```python
import torch

def _softmax(x, axis=-1):
    return torch.softmax(x, dim=axis)
def _gelu(x):
    return torch.nn.functional.gelu(x, approximate="tanh")
def _silu(x):
    return torch.nn.functional.silu(x)
def _sigmoid(x):
    return torch.sigmoid(x)
def _layernorm(x, axis=-1, eps=1e-5):
    m = x.mean(dim=axis, keepdim=True)
    v = x.var(dim=axis, keepdim=True, unbiased=False)
    return (x - m) / torch.sqrt(v + eps)
def _scatter_add(tgt, idx, src, axis=0):
    return tgt.clone().index_add_(axis, idx, src)
def _segment_sum(src, seg, n):
    out = torch.zeros((n,) + src.shape[1:], dtype=src.dtype)
    return out.index_add_(0, seg, src)
def _pad(x, pw):
    flat = tuple(v for pair in reversed(pw) for v in pair)
    return torch.nn.functional.pad(x, flat)

kernel_name = 'recurrent_scan__mha_block_cached__dense_activation_relu__decode'

def setup_inputs():

    _w = (lambda a: (lambda t: t.to(torch.bfloat16) if t.is_floating_point() else t)(torch.as_tensor(a)))
    def _A_setup():
        B, Sq, D = 2, 1, 640
        H, Sk, Dh = 32, 4096, 192
        return {
            "x": _w((lambda *s: torch.randn(*s, dtype=torch.bfloat16) * 0.05)(B, Sq, D)),
            "k_cache": _w((lambda *s: torch.randn(*s, dtype=torch.bfloat16) * 1.6)(B, H, Sk, Dh)),
            "v_cache": _w((lambda *s: torch.randn(*s, dtype=torch.bfloat16) * 0.2)(B, H, Sk, Dh)),
            "wq": _w((lambda *s: torch.randn(*s, dtype=torch.bfloat16) * 1.6)(D, H * Dh) * (D ** -0.5)),
            "wo": _w((lambda *s: torch.randn(*s, dtype=torch.bfloat16) * 0.2)(H * Dh, D) * ((H * Dh) ** -0.5)),
        }
    _A_in = _A_setup()

    def _B_setup():
        B, S, D, Dff = 2, 1, 640, 1536
        return {
            "x": _w((lambda *s: torch.randn(*s, dtype=torch.bfloat16) * 0.05)(B, S, D)),
            "w1": _w((lambda *s: torch.randn(*s, dtype=torch.bfloat16) * 0.1)(D, Dff)),
            "w2": _w((lambda *s: torch.randn(*s, dtype=torch.bfloat16) * 0.1)(Dff, D)),
        }
    _B_in = _B_setup()

    return {
        "A_x": _A_in["x"],
        "A_k_cache": _A_in["k_cache"],
        "A_v_cache": _A_in["v_cache"],
        "A_wq": _A_in["wq"],
        "A_wo": _A_in["wo"],
        "B_x": _B_in["x"],
        "B_w1": _B_in["w1"],
        "B_w2": _B_in["w2"],
    }

def reference(A_x, A_k_cache, A_v_cache, A_wq, A_wo, B_x, B_w1, B_w2):
    def _A_ref(x, k_cache, v_cache, wq, wo):
        B, Sq, D = x.shape
        H, Dh = 32, 192
        q = (lambda x, *d: x.permute(*d))((x @ wq).reshape(B, Sq, H, Dh), 0, 2, 1, 3)
        scores = torch.einsum("bhqd,bhkd->bhqk", q, k_cache) * (Dh ** -0.5)
        p = _softmax(scores, axis=-1)
        o = torch.einsum("bhqk,bhkd->bhqd", p, v_cache)
        return (lambda x, *d: x.permute(*d))(o, 0, 2, 1, 3).reshape(B, Sq, H * Dh) @ wo

    def _B_ref(x, w1, w2):
        h = torch.einsum("bsd,df->bsf", x, w1)
        zero = torch.zeros_like(h)
        h = torch.maximum(h, zero)
        return torch.einsum("bsf,fd->bsd", h, w2)

    x = A_x
    xn = _layernorm(x, axis=-1)
    s = _A_ref(xn, A_k_cache, A_v_cache, A_wq, A_wo)
    g = _silu(_B_ref(xn, B_w1, B_w2))
    return x + s * g
```

```asm
; @launch grid=(256,1,1) block=(320,1,1) lds=162240
.amdgcn_target "amdgcn-amd-amdhsa--gfx950"
.text
.globl recurrent_scan__mha_block_cached__dense_activation_relu__decode_kernel
.p2align 8
.type recurrent_scan__mha_block_cached__dense_activation_relu__decode_kernel,@function
recurrent_scan__mha_block_cached__dense_activation_relu__decode_kernel:
  s_cmp_ge_u32 s2, 256
  s_cbranch_scc1 L_end
  s_load_dwordx16 s[4:19], s[0:1], 0
  s_load_dwordx2 s[20:21], s[0:1], 64
  s_load_dwordx2 s[24:25], s[0:1], 80
  v_lshrrev_b32 v2, 6, v0
  v_and_b32 v1, 63, v0
  s_and_b32 s26, s2, 31
  s_lshr_b32 s27, s2, 5
  v_readfirstlane_b32 s28, v2
  s_mov_b32 s42, 4194304
  s_mov_b32 s43, 0x00020000
  s_cmp_eq_u32 s28, 0
  s_cbranch_scc0 L_stream
  v_lshlrev_b32 v110, 2, v1
  v_add_u32 v7, 162112, v110
  v_mov_b32 v3, 0
  s_mov_b32 exec_hi, 0
  ds_write_b32 v7, v3
  s_mov_b64 exec, -1
  s_cmp_lt_u32 s27, 6
  s_cselect_b32 s33, 1, 0
  s_cmp_lt_u32 s26, 24
  s_cselect_b32 s95, 1, s33
  s_cmp_ge_u32 s27, 3
  s_cselect_b32 s35, 1, 0
  s_mul_i32 s46, s35, 3
  s_sub_u32 s46, s27, s46
  s_lshl_b32 s46, s46, 7
  s_mul_i32 s47, s26, 384
  s_add_u32 s46, s46, s47
  s_mul_i32 s47, s35, 3932160
  s_add_u32 s46, s46, s47
  s_sub_u32 s47, s27, 6
  s_mul_i32 s48, s47, 983040
  s_lshl_b32 s49, s26, 7
  s_add_u32 s48, s48, s49
  s_cmp_eq_u32 s33, 1
  s_cselect_b32 s35, s35, s47
  s_cselect_b32 s46, s46, s48
  s_cselect_b32 s32, 4, 1
  s_mul_i32 s32, s32, 3072
  s_mul_i32 s49, s32, 640
  v_lshrrev_b32 v4, 3, v1
  v_and_b32 v5, 6, v4
  v_and_b32 v6, 7, v1
  v_xor_b32 v5, v5, v6
  v_lshlrev_b32 v5, 4, v5
  v_mul_u32_u24 v6, s32, v4
  v_add_u32 v6, v6, v5
  v_mul_u32_u24 v2, 40, v1
  s_sub_u32 s38, s49, s46
  s_mov_b32 s39, 0x00020000
  s_mov_b32 s98, 2560
  s_mov_b32 s99, 0x00020000
  s_mov_b32 m0, 110592
  s_lshl_b32 s50, s32, 3
  s_mov_b32 s47, 0
  s_cmp_eq_u32 s33, 1
  s_waitcnt lgkmcnt(0)
  s_cselect_b32 s36, s10, s16
  s_cselect_b32 s37, s11, s17
  s_add_u32 s36, s36, s46
  s_addc_u32 s37, s37, 0
  s_mov_b32 s96, s4
  s_mov_b32 s97, s5
  s_cmp_eq_u32 s95, 0
  s_cbranch_scc1 L_h_notile0
  buffer_load_dwordx4 v[10:13], v2, s[96:99], 0 offen
  buffer_load_dwordx4 v[14:17], v2, s[96:99], 0 offen offset:16
  buffer_load_dwordx2 v[18:19], v2, s[96:99], 0 offen offset:32
L_h_dma:
  buffer_load_dwordx4 v6, s[36:39], s47 offen nt lds
  s_add_u32 m0, m0, 1024
  s_add_u32 s47, s47, s50
  buffer_load_dwordx4 v6, s[36:39], s47 offen nt lds
  s_add_u32 m0, m0, 1024
  s_add_u32 s47, s47, s50
  buffer_load_dwordx4 v6, s[36:39], s47 offen nt lds
  s_add_u32 m0, m0, 1024
  s_add_u32 s47, s47, s50
  buffer_load_dwordx4 v6, s[36:39], s47 offen nt lds
  s_add_u32 m0, m0, 1024
  s_add_u32 s47, s47, s50
  s_cmp_lt_u32 m0, 151552
  s_cbranch_scc1 L_h_dma
L_h_notile0:
  s_barrier
  s_load_dwordx2 s[30:31], s[24:25], 0
  s_mov_b32 s46, 1527808
  s_load_dwordx2 s[8:9], s[24:25], s46
  s_mov_b32 s40, s24
  s_mov_b32 s41, s25
  v_lshrrev_b32 v60, 2, v1
  v_and_b32 v8, 6, v60
  v_bfe_u32 v9, v1, 1, 1
  v_xor_b32 v8, v8, v9
  v_and_b32 v9, 1, v1
  v_lshlrev_b32 v9, 3, v9
  v_lshl_add_u32 v9, v60, 7, v9
  v_add_u32 v9, 110592, v9
  v_xor_b32 v60, 0, v8
  v_lshl_add_u32 v60, v60, 4, v9
  v_xor_b32 v61, 2, v8
  v_lshl_add_u32 v61, v61, 4, v9
  v_xor_b32 v62, 4, v8
  v_lshl_add_u32 v62, v62, 4, v9
  v_xor_b32 v63, 6, v8
  v_lshl_add_u32 v63, v63, 4, v9
  v_and_b32 v64, 1, v1
  v_lshrrev_b32 v65, 4, v1
  v_lshlrev_b32 v65, 3, v65
  v_lshlrev_b32 v66, 4, v1
  v_lshlrev_b32 v67, 1, v1
  s_lshl_b32 s44, s26, 3
  s_add_u32 s45, s44, s27
  s_lshl_b32 s45, s45, 10
  s_lshl_b32 s44, s44, 10
  s_add_u32 s94, s45, 4096
  s_mov_b32 s93, 0
  s_cmp_eq_u32 s95, 0
  s_cbranch_scc1 L_h_notile1
  s_waitcnt vmcnt(40)
  s_mov_b32 s46, 0xffff0000
  v_lshlrev_b32 v20, 16, v10
  v_and_b32 v21, s46, v10
  v_lshlrev_b32 v22, 16, v11
  v_and_b32 v23, s46, v11
  v_lshlrev_b32 v24, 16, v12
  v_and_b32 v25, s46, v12
  v_lshlrev_b32 v26, 16, v13
  v_and_b32 v27, s46, v13
  v_lshlrev_b32 v28, 16, v14
  v_and_b32 v29, s46, v14
  v_lshlrev_b32 v30, 16, v15
  v_and_b32 v31, s46, v15
  v_lshlrev_b32 v32, 16, v16
  v_and_b32 v33, s46, v16
  v_lshlrev_b32 v34, 16, v17
  v_and_b32 v35, s46, v17
  v_lshlrev_b32 v36, 16, v18
  v_and_b32 v37, s46, v18
  v_lshlrev_b32 v38, 16, v19
  v_and_b32 v39, s46, v19
  v_pk_add_f32 v[40:41], v[20:21], v[22:23]
  v_pk_add_f32 v[42:43], v[24:25], v[26:27]
  v_pk_add_f32 v[40:41], v[40:41], v[28:29]
  v_pk_add_f32 v[42:43], v[42:43], v[30:31]
  v_pk_add_f32 v[40:41], v[40:41], v[32:33]
  v_pk_add_f32 v[42:43], v[42:43], v[34:35]
  v_pk_add_f32 v[40:41], v[40:41], v[36:37]
  v_pk_add_f32 v[42:43], v[42:43], v[38:39]
  v_pk_add_f32 v[40:41], v[40:41], v[42:43]
  v_add_f32 v8, v40, v41
  s_nop 1
  v_add_f32_dpp v8, v8, v8 quad_perm:[1,0,3,2] row_mask:0xf bank_mask:0xf
  s_nop 1
  v_add_f32_dpp v8, v8, v8 quad_perm:[2,3,0,1] row_mask:0xf bank_mask:0xf
  s_nop 1
  v_add_f32_dpp v8, v8, v8 row_half_mirror row_mask:0xf bank_mask:0xf
  s_nop 1
  v_add_f32_dpp v8, v8, v8 row_mirror row_mask:0xf bank_mask:0xf
  v_mov_b32 v9, v8
  s_nop 1
  v_permlane16_swap_b32 v8, v9
  v_add_f32 v8, v8, v9
  v_mul_f32 v8, 0x3acccccd, v8
  v_pk_add_f32 v[40:41], v[20:21], v[8:9] op_sel_hi:[1,0] neg_lo:[0,1] neg_hi:[0,1]
  v_pk_add_f32 v[42:43], v[22:23], v[8:9] op_sel_hi:[1,0] neg_lo:[0,1] neg_hi:[0,1]
  v_pk_add_f32 v[44:45], v[24:25], v[8:9] op_sel_hi:[1,0] neg_lo:[0,1] neg_hi:[0,1]
  v_pk_add_f32 v[46:47], v[26:27], v[8:9] op_sel_hi:[1,0] neg_lo:[0,1] neg_hi:[0,1]
  v_pk_add_f32 v[48:49], v[28:29], v[8:9] op_sel_hi:[1,0] neg_lo:[0,1] neg_hi:[0,1]
  v_pk_add_f32 v[50:51], v[30:31], v[8:9] op_sel_hi:[1,0] neg_lo:[0,1] neg_hi:[0,1]
  v_pk_add_f32 v[52:53], v[32:33], v[8:9] op_sel_hi:[1,0] neg_lo:[0,1] neg_hi:[0,1]
  v_pk_add_f32 v[54:55], v[34:35], v[8:9] op_sel_hi:[1,0] neg_lo:[0,1] neg_hi:[0,1]
  v_pk_add_f32 v[56:57], v[36:37], v[8:9] op_sel_hi:[1,0] neg_lo:[0,1] neg_hi:[0,1]
  v_pk_add_f32 v[58:59], v[38:39], v[8:9] op_sel_hi:[1,0] neg_lo:[0,1] neg_hi:[0,1]
  v_pk_mul_f32 v[10:11], v[40:41], v[40:41]
  v_pk_mul_f32 v[12:13], v[42:43], v[42:43]
  v_pk_fma_f32 v[10:11], v[44:45], v[44:45], v[10:11]
  v_pk_fma_f32 v[12:13], v[46:47], v[46:47], v[12:13]
  v_pk_fma_f32 v[10:11], v[48:49], v[48:49], v[10:11]
  v_pk_fma_f32 v[12:13], v[50:51], v[50:51], v[12:13]
  v_pk_fma_f32 v[10:11], v[52:53], v[52:53], v[10:11]
  v_pk_fma_f32 v[12:13], v[54:55], v[54:55], v[12:13]
  v_pk_fma_f32 v[10:11], v[56:57], v[56:57], v[10:11]
  v_pk_fma_f32 v[12:13], v[58:59], v[58:59], v[12:13]
  v_pk_add_f32 v[10:11], v[10:11], v[12:13]
  v_add_f32 v10, v10, v11
  v_cvt_pk_bf16_f32 v8, v8, v8
  v_and_b32 v8, s46, v8
  s_nop 1
  v_add_f32_dpp v10, v10, v10 quad_perm:[1,0,3,2] row_mask:0xf bank_mask:0xf
  s_nop 1
  v_add_f32_dpp v10, v10, v10 quad_perm:[2,3,0,1] row_mask:0xf bank_mask:0xf
  s_nop 1
  v_add_f32_dpp v10, v10, v10 row_half_mirror row_mask:0xf bank_mask:0xf
  s_nop 1
  v_add_f32_dpp v10, v10, v10 row_mirror row_mask:0xf bank_mask:0xf
  v_mov_b32 v11, v10
  s_nop 1
  v_permlane16_swap_b32 v10, v11
  v_add_f32 v10, v10, v11
  v_mul_f32 v10, 0x3acccccd, v10
  v_cvt_pk_bf16_f32 v10, v10, v10
  v_and_b32 v10, s46, v10
  v_add_f32 v10, 0x3727c5ac, v10
  v_cvt_pk_bf16_f32 v10, v10, v10
  v_and_b32 v10, s46, v10
  v_sqrt_f32 v10, v10
  v_pk_add_f32 v[40:41], v[20:21], v[8:9] op_sel_hi:[1,0] neg_lo:[0,1] neg_hi:[0,1]
  v_pk_add_f32 v[42:43], v[22:23], v[8:9] op_sel_hi:[1,0] neg_lo:[0,1] neg_hi:[0,1]
  v_pk_add_f32 v[44:45], v[24:25], v[8:9] op_sel_hi:[1,0] neg_lo:[0,1] neg_hi:[0,1]
  v_pk_add_f32 v[46:47], v[26:27], v[8:9] op_sel_hi:[1,0] neg_lo:[0,1] neg_hi:[0,1]
  v_pk_add_f32 v[48:49], v[28:29], v[8:9] op_sel_hi:[1,0] neg_lo:[0,1] neg_hi:[0,1]
  v_pk_add_f32 v[50:51], v[30:31], v[8:9] op_sel_hi:[1,0] neg_lo:[0,1] neg_hi:[0,1]
  v_pk_add_f32 v[52:53], v[32:33], v[8:9] op_sel_hi:[1,0] neg_lo:[0,1] neg_hi:[0,1]
  v_pk_add_f32 v[54:55], v[34:35], v[8:9] op_sel_hi:[1,0] neg_lo:[0,1] neg_hi:[0,1]
  v_pk_add_f32 v[56:57], v[36:37], v[8:9] op_sel_hi:[1,0] neg_lo:[0,1] neg_hi:[0,1]
  v_pk_add_f32 v[58:59], v[38:39], v[8:9] op_sel_hi:[1,0] neg_lo:[0,1] neg_hi:[0,1]
  v_cvt_pk_bf16_f32 v10, v10, v10
  v_and_b32 v10, s46, v10
  v_rcp_f32 v10, v10
  v_cvt_pk_bf16_f32 v40, v40, v41
  v_cvt_pk_bf16_f32 v42, v42, v43
  v_cvt_pk_bf16_f32 v44, v44, v45
  v_cvt_pk_bf16_f32 v46, v46, v47
  v_cvt_pk_bf16_f32 v48, v48, v49
  v_cvt_pk_bf16_f32 v50, v50, v51
  v_cvt_pk_bf16_f32 v52, v52, v53
  v_cvt_pk_bf16_f32 v54, v54, v55
  v_cvt_pk_bf16_f32 v56, v56, v57
  v_cvt_pk_bf16_f32 v58, v58, v59
  v_and_b32 v41, s46, v40
  v_lshlrev_b32 v40, 16, v40
  v_and_b32 v43, s46, v42
  v_lshlrev_b32 v42, 16, v42
  v_and_b32 v45, s46, v44
  v_lshlrev_b32 v44, 16, v44
  v_and_b32 v47, s46, v46
  v_lshlrev_b32 v46, 16, v46
  v_and_b32 v49, s46, v48
  v_lshlrev_b32 v48, 16, v48
  v_and_b32 v51, s46, v50
  v_lshlrev_b32 v50, 16, v50
  v_and_b32 v53, s46, v52
  v_lshlrev_b32 v52, 16, v52
  v_and_b32 v55, s46, v54
  v_lshlrev_b32 v54, 16, v54
  v_and_b32 v57, s46, v56
  v_lshlrev_b32 v56, 16, v56
  v_and_b32 v59, s46, v58
  v_lshlrev_b32 v58, 16, v58
  v_pk_mul_f32 v[40:41], v[40:41], v[10:11] op_sel_hi:[1,0]
  v_pk_mul_f32 v[42:43], v[42:43], v[10:11] op_sel_hi:[1,0]
  v_pk_mul_f32 v[44:45], v[44:45], v[10:11] op_sel_hi:[1,0]
  v_pk_mul_f32 v[46:47], v[46:47], v[10:11] op_sel_hi:[1,0]
  v_pk_mul_f32 v[48:49], v[48:49], v[10:11] op_sel_hi:[1,0]
  v_pk_mul_f32 v[50:51], v[50:51], v[10:11] op_sel_hi:[1,0]
  v_pk_mul_f32 v[52:53], v[52:53], v[10:11] op_sel_hi:[1,0]
  v_pk_mul_f32 v[54:55], v[54:55], v[10:11] op_sel_hi:[1,0]
  v_pk_mul_f32 v[56:57], v[56:57], v[10:11] op_sel_hi:[1,0]
  v_pk_mul_f32 v[58:59], v[58:59], v[10:11] op_sel_hi:[1,0]
  v_cvt_pk_bf16_f32 v20, v40, v41
  v_cvt_pk_bf16_f32 v21, v42, v43
  v_cvt_pk_bf16_f32 v22, v44, v45
  v_cvt_pk_bf16_f32 v23, v46, v47
  v_cvt_pk_bf16_f32 v24, v48, v49
  v_cvt_pk_bf16_f32 v25, v50, v51
  v_cvt_pk_bf16_f32 v26, v52, v53
  v_cvt_pk_bf16_f32 v27, v54, v55
  v_cvt_pk_bf16_f32 v28, v56, v57
  v_cvt_pk_bf16_f32 v29, v58, v59
  v_add_u32 v2, 157696, v2
  ds_write_b64 v2, v[20:21] offset:0
  ds_write_b64 v2, v[22:23] offset:8
  ds_write_b64 v2, v[24:25] offset:16
  ds_write_b64 v2, v[26:27] offset:24
  ds_write_b64 v2, v[28:29] offset:32
  s_mul_i32 s46, s35, 640
  s_add_u32 s46, s46, 157696
  v_mul_u32_u24 v9, 1280, v64
  v_add3_u32 v9, v9, v65, s46
  s_waitcnt lgkmcnt(0)
  ds_read2_b64 v[112:115], v9 offset0:0 offset1:4
  ds_read2_b64 v[116:119], v9 offset0:8 offset1:12
  ds_read2_b64 v[120:123], v9 offset0:16 offset1:20
  ds_read2_b64 v[124:127], v9 offset0:24 offset1:28
  ds_read2_b64 v[128:131], v9 offset0:32 offset1:36
  ds_read2_b64 v[132:135], v9 offset0:40 offset1:44
  ds_read2_b64 v[136:139], v9 offset0:48 offset1:52
  ds_read2_b64 v[140:143], v9 offset0:56 offset1:60
  ds_read2_b64 v[144:147], v9 offset0:64 offset1:68
  ds_read2_b64 v[148:151], v9 offset0:72 offset1:76
  s_waitcnt vmcnt(36)
  ds_read_b64_tr_b16 v[152:153], v60 offset:0
  ds_read_b64_tr_b16 v[154:155], v60 offset:2048
  ds_read_b64_tr_b16 v[156:157], v61 offset:0
  ds_read_b64_tr_b16 v[158:159], v61 offset:2048
  ds_read_b64_tr_b16 v[160:161], v62 offset:0
  ds_read_b64_tr_b16 v[162:163], v62 offset:2048
  ds_read_b64_tr_b16 v[164:165], v63 offset:0
  ds_read_b64_tr_b16 v[166:167], v63 offset:2048
  s_waitcnt vmcnt(32)
  ds_read_b64_tr_b16 v[168:169], v60 offset:4096
  ds_read_b64_tr_b16 v[170:171], v60 offset:6144
  ds_read_b64_tr_b16 v[172:173], v61 offset:4096
  ds_read_b64_tr_b16 v[174:175], v61 offset:6144
  ds_read_b64_tr_b16 v[176:177], v62 offset:4096
  ds_read_b64_tr_b16 v[178:179], v62 offset:6144
  ds_read_b64_tr_b16 v[180:181], v63 offset:4096
  ds_read_b64_tr_b16 v[182:183], v63 offset:6144
  s_waitcnt lgkmcnt(8)
  v_mfma_f32_16x16x32_bf16 v[184:187], v[112:115], v[152:155], 0
  v_mfma_f32_16x16x32_bf16 v[188:191], v[112:115], v[156:159], 0
  v_mfma_f32_16x16x32_bf16 v[192:195], v[112:115], v[160:163], 0
  v_mfma_f32_16x16x32_bf16 v[196:199], v[112:115], v[164:167], 0
  s_waitcnt vmcnt(28)
  ds_read_b64_tr_b16 v[152:153], v60 offset:8192
  ds_read_b64_tr_b16 v[154:155], v60 offset:10240
  ds_read_b64_tr_b16 v[156:157], v61 offset:8192
  ds_read_b64_tr_b16 v[158:159], v61 offset:10240
  ds_read_b64_tr_b16 v[160:161], v62 offset:8192
  ds_read_b64_tr_b16 v[162:163], v62 offset:10240
  ds_read_b64_tr_b16 v[164:165], v63 offset:8192
  ds_read_b64_tr_b16 v[166:167], v63 offset:10240
  s_waitcnt lgkmcnt(8)
  v_mfma_f32_16x16x32_bf16 v[184:187], v[116:119], v[168:171], v[184:187]
  v_mfma_f32_16x16x32_bf16 v[188:191], v[116:119], v[172:175], v[188:191]
  v_mfma_f32_16x16x32_bf16 v[192:195], v[116:119], v[176:179], v[192:195]
  v_mfma_f32_16x16x32_bf16 v[196:199], v[116:119], v[180:183], v[196:199]
  s_waitcnt vmcnt(24)
  ds_read_b64_tr_b16 v[168:169], v60 offset:12288
  ds_read_b64_tr_b16 v[170:171], v60 offset:14336
  ds_read_b64_tr_b16 v[172:173], v61 offset:12288
  ds_read_b64_tr_b16 v[174:175], v61 offset:14336
  ds_read_b64_tr_b16 v[176:177], v62 offset:12288
  ds_read_b64_tr_b16 v[178:179], v62 offset:14336
  ds_read_b64_tr_b16 v[180:181], v63 offset:12288
  ds_read_b64_tr_b16 v[182:183], v63 offset:14336
  s_waitcnt lgkmcnt(8)
  v_mfma_f32_16x16x32_bf16 v[184:187], v[120:123], v[152:155], v[184:187]
  v_mfma_f32_16x16x32_bf16 v[188:191], v[120:123], v[156:159], v[188:191]
  v_mfma_f32_16x16x32_bf16 v[192:195], v[120:123], v[160:163], v[192:195]
  v_mfma_f32_16x16x32_bf16 v[196:199], v[120:123], v[164:167], v[196:199]
  s_waitcnt vmcnt(20)
  ds_read_b64_tr_b16 v[152:153], v60 offset:16384
  ds_read_b64_tr_b16 v[154:155], v60 offset:18432
  ds_read_b64_tr_b16 v[156:157], v61 offset:16384
  ds_read_b64_tr_b16 v[158:159], v61 offset:18432
  ds_read_b64_tr_b16 v[160:161], v62 offset:16384
  ds_read_b64_tr_b16 v[162:163], v62 offset:18432
  ds_read_b64_tr_b16 v[164:165], v63 offset:16384
  ds_read_b64_tr_b16 v[166:167], v63 offset:18432
  s_waitcnt lgkmcnt(8)
  v_mfma_f32_16x16x32_bf16 v[184:187], v[124:127], v[168:171], v[184:187]
  v_mfma_f32_16x16x32_bf16 v[188:191], v[124:127], v[172:175], v[188:191]
  v_mfma_f32_16x16x32_bf16 v[192:195], v[124:127], v[176:179], v[192:195]
  v_mfma_f32_16x16x32_bf16 v[196:199], v[124:127], v[180:183], v[196:199]
  s_waitcnt vmcnt(16)
  ds_read_b64_tr_b16 v[168:169], v60 offset:20480
  ds_read_b64_tr_b16 v[170:171], v60 offset:22528
  ds_read_b64_tr_b16 v[172:173], v61 offset:20480
  ds_read_b64_tr_b16 v[174:175], v61 offset:22528
  ds_read_b64_tr_b16 v[176:177], v62 offset:20480
  ds_read_b64_tr_b16 v[178:179], v62 offset:22528
  ds_read_b64_tr_b16 v[180:181], v63 offset:20480
  ds_read_b64_tr_b16 v[182:183], v63 offset:22528
  s_waitcnt lgkmcnt(8)
  v_mfma_f32_16x16x32_bf16 v[184:187], v[128:131], v[152:155], v[184:187]
  v_mfma_f32_16x16x32_bf16 v[188:191], v[128:131], v[156:159], v[188:191]
  v_mfma_f32_16x16x32_bf16 v[192:195], v[128:131], v[160:163], v[192:195]
  v_mfma_f32_16x16x32_bf16 v[196:199], v[128:131], v[164:167], v[196:199]
  s_waitcnt vmcnt(12)
  ds_read_b64_tr_b16 v[152:153], v60 offset:24576
  ds_read_b64_tr_b16 v[154:155], v60 offset:26624
  ds_read_b64_tr_b16 v[156:157], v61 offset:24576
  ds_read_b64_tr_b16 v[158:159], v61 offset:26624
  ds_read_b64_tr_b16 v[160:161], v62 offset:24576
  ds_read_b64_tr_b16 v[162:163], v62 offset:26624
  ds_read_b64_tr_b16 v[164:165], v63 offset:24576
  ds_read_b64_tr_b16 v[166:167], v63 offset:26624
  s_waitcnt lgkmcnt(8)
  v_mfma_f32_16x16x32_bf16 v[184:187], v[132:135], v[168:171], v[184:187]
  v_mfma_f32_16x16x32_bf16 v[188:191], v[132:135], v[172:175], v[188:191]
  v_mfma_f32_16x16x32_bf16 v[192:195], v[132:135], v[176:179], v[192:195]
  v_mfma_f32_16x16x32_bf16 v[196:199], v[132:135], v[180:183], v[196:199]
  s_waitcnt vmcnt(8)
  ds_read_b64_tr_b16 v[168:169], v60 offset:28672
  ds_read_b64_tr_b16 v[170:171], v60 offset:30720
  ds_read_b64_tr_b16 v[172:173], v61 offset:28672
  ds_read_b64_tr_b16 v[174:175], v61 offset:30720
  ds_read_b64_tr_b16 v[176:177], v62 offset:28672
  ds_read_b64_tr_b16 v[178:179], v62 offset:30720
  ds_read_b64_tr_b16 v[180:181], v63 offset:28672
  ds_read_b64_tr_b16 v[182:183], v63 offset:30720
  s_waitcnt lgkmcnt(8)
  v_mfma_f32_16x16x32_bf16 v[184:187], v[136:139], v[152:155], v[184:187]
  v_mfma_f32_16x16x32_bf16 v[188:191], v[136:139], v[156:159], v[188:191]
  v_mfma_f32_16x16x32_bf16 v[192:195], v[136:139], v[160:163], v[192:195]
  v_mfma_f32_16x16x32_bf16 v[196:199], v[136:139], v[164:167], v[196:199]
  s_waitcnt vmcnt(4)
  ds_read_b64_tr_b16 v[152:153], v60 offset:32768
  ds_read_b64_tr_b16 v[154:155], v60 offset:34816
  ds_read_b64_tr_b16 v[156:157], v61 offset:32768
  ds_read_b64_tr_b16 v[158:159], v61 offset:34816
  ds_read_b64_tr_b16 v[160:161], v62 offset:32768
  ds_read_b64_tr_b16 v[162:163], v62 offset:34816
  ds_read_b64_tr_b16 v[164:165], v63 offset:32768
  ds_read_b64_tr_b16 v[166:167], v63 offset:34816
  s_waitcnt lgkmcnt(8)
  v_mfma_f32_16x16x32_bf16 v[184:187], v[140:143], v[168:171], v[184:187]
  v_mfma_f32_16x16x32_bf16 v[188:191], v[140:143], v[172:175], v[188:191]
  v_mfma_f32_16x16x32_bf16 v[192:195], v[140:143], v[176:179], v[192:195]
  v_mfma_f32_16x16x32_bf16 v[196:199], v[140:143], v[180:183], v[196:199]
  s_waitcnt vmcnt(0)
  ds_read_b64_tr_b16 v[168:169], v60 offset:36864
  ds_read_b64_tr_b16 v[170:171], v60 offset:38912
  ds_read_b64_tr_b16 v[172:173], v61 offset:36864
  ds_read_b64_tr_b16 v[174:175], v61 offset:38912
  ds_read_b64_tr_b16 v[176:177], v62 offset:36864
  ds_read_b64_tr_b16 v[178:179], v62 offset:38912
  ds_read_b64_tr_b16 v[180:181], v63 offset:36864
  ds_read_b64_tr_b16 v[182:183], v63 offset:38912
  s_waitcnt lgkmcnt(8)
  v_mfma_f32_16x16x32_bf16 v[184:187], v[144:147], v[152:155], v[184:187]
  v_mfma_f32_16x16x32_bf16 v[188:191], v[144:147], v[156:159], v[188:191]
  v_mfma_f32_16x16x32_bf16 v[192:195], v[144:147], v[160:163], v[192:195]
  v_mfma_f32_16x16x32_bf16 v[196:199], v[144:147], v[164:167], v[196:199]
  s_waitcnt lgkmcnt(0)
  v_mfma_f32_16x16x32_bf16 v[184:187], v[148:151], v[168:171], v[184:187]
  v_mfma_f32_16x16x32_bf16 v[188:191], v[148:151], v[172:175], v[188:191]
  v_mfma_f32_16x16x32_bf16 v[192:195], v[148:151], v[176:179], v[192:195]
  v_mfma_f32_16x16x32_bf16 v[196:199], v[148:151], v[180:183], v[196:199]
L_h_notile1:
  s_waitcnt lgkmcnt(0)
  s_add_u32 s30, s30, 0x7f4a7c15
  s_addc_u32 s31, s31, 0x9e3779b9
  v_mov_b32 v16, s30
  v_mov_b32 v17, s31
  s_add_u32 s30, s30, s8
  s_addc_u32 s31, s31, s9
  s_add_u32 s8, s8, 0x27d4eb4f
  s_addc_u32 s9, s9, 0xc2b2ae3d
  v_mov_b32 v18, s8
  v_mov_b32 v19, s9
  s_add_u32 s29, s44, 4096
  s_add_u32 s50, s29, 4096
  v_mov_b32 v70, s30
  v_mov_b32 v71, s31
  v_mov_b32 v234, s30
  v_mov_b32 v235, s31
  s_cmp_eq_u32 s95, 0
  s_cbranch_scc1 L_h_notile2
  v_mov_b32 v232, v184
  v_mov_b32 v233, v185
  s_nop 0
  v_mov_b32_dpp v232, v188 quad_perm:[0,1,2,3] row_mask:0x2 bank_mask:0xf
  v_mov_b32_dpp v233, v189 quad_perm:[0,1,2,3] row_mask:0x2 bank_mask:0xf
  s_nop 0
  v_mov_b32_dpp v232, v192 quad_perm:[0,1,2,3] row_mask:0x4 bank_mask:0xf
  v_mov_b32_dpp v233, v193 quad_perm:[0,1,2,3] row_mask:0x4 bank_mask:0xf
  s_nop 0
  v_mov_b32_dpp v232, v196 quad_perm:[0,1,2,3] row_mask:0x8 bank_mask:0xf
  v_mov_b32_dpp v233, v197 quad_perm:[0,1,2,3] row_mask:0x8 bank_mask:0xf
  s_cmp_eq_u32 s93, 0
  s_cbranch_scc0 L_pb1
  buffer_store_dwordx4 v[232:235], v66, s[40:43], s94 offen offset:0
L_pbd2:
L_h_notile2:
  s_mov_b32 s48, 63
  s_bitset0_b32 s48, s27
  s_cmp_eq_u32 s27, 0
  s_cbranch_scc0 L_qo3
  v_mov_b32 v72, v232
  v_mov_b32 v73, v233
L_qo3:
  s_cmp_eq_u32 s27, 1
  s_cbranch_scc0 L_qo4
  v_mov_b32 v76, v232
  v_mov_b32 v77, v233
L_qo4:
  s_cmp_eq_u32 s27, 2
  s_cbranch_scc0 L_qo5
  v_mov_b32 v80, v232
  v_mov_b32 v81, v233
L_qo5:
  s_cmp_eq_u32 s27, 3
  s_cbranch_scc0 L_qo6
  v_mov_b32 v84, v232
  v_mov_b32 v85, v233
L_qo6:
  s_cmp_eq_u32 s27, 4
  s_cbranch_scc0 L_qo7
  v_mov_b32 v88, v232
  v_mov_b32 v89, v233
L_qo7:
  s_cmp_eq_u32 s27, 5
  s_cbranch_scc0 L_qo8
  v_mov_b32 v92, v232
  v_mov_b32 v93, v233
L_qo8:
  s_mov_b32 s47, 400000
L_g9:
  s_bitcmp1_b32 s48, 0
  s_cbranch_scc0 L_gs11
  buffer_load_dwordx4 v[72:75], v66, s[40:43], s29 offen offset:0 sc1
L_gs11:
  s_bitcmp1_b32 s48, 1
  s_cbranch_scc0 L_gs12
  buffer_load_dwordx4 v[76:79], v66, s[40:43], s29 offen offset:1024 sc1
L_gs12:
  s_bitcmp1_b32 s48, 2
  s_cbranch_scc0 L_gs13
  buffer_load_dwordx4 v[80:83], v66, s[40:43], s29 offen offset:2048 sc1
L_gs13:
  s_bitcmp1_b32 s48, 3
  s_cbranch_scc0 L_gs14
  buffer_load_dwordx4 v[84:87], v66, s[40:43], s29 offen offset:3072 sc1
L_gs14:
  s_bitcmp1_b32 s48, 4
  s_cbranch_scc0 L_gs15
  buffer_load_dwordx4 v[88:91], v66, s[40:43], s50 offen offset:0 sc1
L_gs15:
  s_bitcmp1_b32 s48, 5
  s_cbranch_scc0 L_gs16
  buffer_load_dwordx4 v[92:95], v66, s[40:43], s50 offen offset:1024 sc1
L_gs16:
  s_waitcnt vmcnt(0)
  v_cmp_ne_u64 vcc, s[30:31], v[74:75]
  s_cbranch_vccnz L_gc17
  s_bitset0_b32 s48, 0
L_gc17:
  v_cmp_ne_u64 vcc, s[30:31], v[78:79]
  s_cbranch_vccnz L_gc18
  s_bitset0_b32 s48, 1
L_gc18:
  v_cmp_ne_u64 vcc, s[30:31], v[82:83]
  s_cbranch_vccnz L_gc19
  s_bitset0_b32 s48, 2
L_gc19:
  v_cmp_ne_u64 vcc, s[30:31], v[86:87]
  s_cbranch_vccnz L_gc20
  s_bitset0_b32 s48, 3
L_gc20:
  v_cmp_ne_u64 vcc, s[30:31], v[90:91]
  s_cbranch_vccnz L_gc21
  s_bitset0_b32 s48, 4
L_gc21:
  v_cmp_ne_u64 vcc, s[30:31], v[94:95]
  s_cbranch_vccnz L_gc22
  s_bitset0_b32 s48, 5
L_gc22:
  s_cmp_eq_u32 s48, 0
  s_cbranch_scc1 L_gd10
  s_cmp_eq_u32 s47, 399976
  s_cbranch_scc0 L_gt23
  s_mov_b32 s93, 1
  s_cmp_eq_u32 s95, 0
  s_cbranch_scc1 L_rq24
  buffer_store_dwordx4 v[232:235], v66, s[40:43], s94 offen sc1
  s_waitcnt vmcnt(0)
L_rq24:
L_gt23:
  s_sub_u32 s47, s47, 1
  s_cbranch_scc0 L_g9
L_gd10:
  v_add_u32 v9, 160256, v67
  v_add_f32 v20, v72, v84
  v_add_f32 v21, v73, v85
  v_cvt_pk_bf16_f32 v20, v20, v21
  ds_write_b16 v9, v20 offset:0
  ds_write_b16_d16_hi v9, v20 offset:384
  v_add_f32 v22, v76, v88
  v_add_f32 v23, v77, v89
  v_cvt_pk_bf16_f32 v22, v22, v23
  ds_write_b16 v9, v22 offset:128
  ds_write_b16_d16_hi v9, v22 offset:512
  v_add_f32 v24, v80, v92
  v_add_f32 v25, v81, v93
  v_cvt_pk_bf16_f32 v24, v24, v25
  ds_write_b16 v9, v24 offset:256
  ds_write_b16_d16_hi v9, v24 offset:640
  v_mov_b32 v8, 1
  s_waitcnt lgkmcnt(0)
  s_mov_b64 exec, 1
  ds_write_b32 v7, v8
  s_mov_b64 exec, -1
  s_cmp_eq_u32 s95, s33
  s_cbranch_scc1 L_h_noffn
  s_mul_i32 s46, s26, 81920
  s_mul_i32 s47, s35, 640
  s_add_u32 s46, s46, s47
  s_add_u32 s36, s18, s46
  s_addc_u32 s37, s19, 0
  s_sub_u32 s38, 1966080, s46
  v_mul_u32_u24 v6, 1280, v4
  v_add_u32 v6, v6, v5
  s_mov_b32 s46, 110592
  s_mov_b32 s47, 0
L_f_dma:
  s_add_u32 m0, s46, 0
  s_nop 0
  buffer_load_dwordx4 v6, s[36:39], s47 offen offset:0 nt lds
  s_add_u32 m0, s46, 8064
  s_nop 0
  buffer_load_dwordx4 v6, s[36:39], s47 offen offset:128 nt lds
  s_add_u32 m0, s46, 16128
  s_nop 0
  buffer_load_dwordx4 v6, s[36:39], s47 offen offset:256 nt lds
  s_add_u32 m0, s46, 24192
  s_nop 0
  buffer_load_dwordx4 v6, s[36:39], s47 offen offset:384 nt lds
  s_add_u32 m0, s46, 32256
  s_nop 0
  buffer_load_dwordx4 v6, s[36:39], s47 offen offset:512 nt lds
  s_waitcnt vmcnt(5)
  s_add_u32 s46, s46, 1024
  s_add_u32 s47, s47, 10240
  s_cmp_lt_u32 s46, 118784
  s_cbranch_scc1 L_f_dma
  s_mov_b32 s48, 3
  s_mov_b32 s47, 400000
L_g25:
  s_bitcmp1_b32 s48, 0
  s_cbranch_scc0 L_gs27
  buffer_load_dwordx4 v[72:75], v66, s[40:43], s50 offen offset:2048 sc1
L_gs27:
  s_bitcmp1_b32 s48, 1
  s_cbranch_scc0 L_gs28
  buffer_load_dwordx4 v[76:79], v66, s[40:43], s50 offen offset:3072 sc1
L_gs28:
  s_waitcnt vmcnt(0)
  v_cmp_ne_u64 vcc, s[30:31], v[74:75]
  s_cbranch_vccnz L_gc29
  s_bitset0_b32 s48, 0
L_gc29:
  v_cmp_ne_u64 vcc, s[30:31], v[78:79]
  s_cbranch_vccnz L_gc30
  s_bitset0_b32 s48, 1
L_gc30:
  s_cmp_eq_u32 s48, 0
  s_cbranch_scc1 L_gd26
  s_sleep 8
  s_cmp_eq_u32 s47, 399976
  s_cbranch_scc0 L_gt31
  s_mov_b32 s93, 1
  s_cmp_eq_u32 s95, 0
  s_cbranch_scc1 L_rq32
  buffer_store_dwordx4 v[232:235], v66, s[40:43], s94 offen sc1
  s_waitcnt vmcnt(0)
L_rq32:
L_gt31:
  s_sub_u32 s47, s47, 1
  s_cbranch_scc0 L_g25
L_gd26:
  v_add_f32 v20, v72, v76
  v_add_f32 v21, v73, v77
  v_max_f32 v20, 0, v20
  v_max_f32 v21, 0, v21
  v_cvt_pk_bf16_f32 v20, v20, v21
  v_add_u32 v9, 161792, v67
  ds_write_b16 v9, v20
  ds_write_b16_d16_hi v9, v20 offset:128
  v_lshl_add_u32 v9, v64, 7, v65
  v_add_u32 v9, 161792, v9
  s_waitcnt lgkmcnt(0)
  ds_read2_b64 v[112:115], v9 offset0:0 offset1:4
  ds_read2_b64 v[116:119], v9 offset0:8 offset1:12
  v_lshrrev_b32 v8, 4, v1
  v_mul_u32_u24 v8, 6144, v8
  v_and_b32 v9, 15, v1
  v_lshl_add_u32 v9, v9, 4, v8
  s_mul_i32 s46, s35, 122880
  s_lshl_b32 s47, s26, 8
  s_add_u32 s46, s46, s47
  s_add_u32 s46, s46, 856064
  s_mov_b32 s47, 0
L_f_blk:
  ds_read_b64_tr_b16 v[152:153], v60 offset:0
  ds_read_b64_tr_b16 v[154:155], v60 offset:2048
  ds_read_b64_tr_b16 v[156:157], v61 offset:0
  ds_read_b64_tr_b16 v[158:159], v61 offset:2048
  ds_read_b64_tr_b16 v[160:161], v62 offset:0
  ds_read_b64_tr_b16 v[162:163], v62 offset:2048
  ds_read_b64_tr_b16 v[164:165], v63 offset:0
  ds_read_b64_tr_b16 v[166:167], v63 offset:2048
  s_waitcnt lgkmcnt(0)
  ds_read_b64_tr_b16 v[168:169], v60 offset:4096
  ds_read_b64_tr_b16 v[170:171], v60 offset:6144
  ds_read_b64_tr_b16 v[172:173], v61 offset:4096
  ds_read_b64_tr_b16 v[174:175], v61 offset:6144
  ds_read_b64_tr_b16 v[176:177], v62 offset:4096
  ds_read_b64_tr_b16 v[178:179], v62 offset:6144
  ds_read_b64_tr_b16 v[180:181], v63 offset:4096
  ds_read_b64_tr_b16 v[182:183], v63 offset:6144
  s_waitcnt lgkmcnt(0)
  v_mfma_f32_16x16x32_bf16 v[184:187], v[112:115], v[152:155], 0
  v_mfma_f32_16x16x32_bf16 v[188:191], v[112:115], v[156:159], 0
  v_mfma_f32_16x16x32_bf16 v[192:195], v[112:115], v[160:163], 0
  v_mfma_f32_16x16x32_bf16 v[196:199], v[112:115], v[164:167], 0
  v_mfma_f32_16x16x32_bf16 v[184:187], v[116:119], v[168:171], v[184:187]
  v_mfma_f32_16x16x32_bf16 v[188:191], v[116:119], v[172:175], v[188:191]
  v_mfma_f32_16x16x32_bf16 v[192:195], v[116:119], v[176:179], v[192:195]
  v_mfma_f32_16x16x32_bf16 v[196:199], v[116:119], v[180:183], v[196:199]
  v_add_u32 v60, 8192, v60
  v_add_u32 v61, 8192, v61
  v_add_u32 v62, 8192, v62
  v_add_u32 v63, 8192, v63
  s_nop 7
  v_mov_b32 v68, v184
  v_mov_b32 v69, v185
  s_nop 0
  v_mov_b32_dpp v68, v188 quad_perm:[0,1,2,3] row_mask:0x2 bank_mask:0xf
  v_mov_b32_dpp v69, v189 quad_perm:[0,1,2,3] row_mask:0x2 bank_mask:0xf
  s_nop 0
  v_mov_b32_dpp v68, v192 quad_perm:[0,1,2,3] row_mask:0x4 bank_mask:0xf
  v_mov_b32_dpp v69, v193 quad_perm:[0,1,2,3] row_mask:0x4 bank_mask:0xf
  s_nop 0
  v_mov_b32_dpp v68, v196 quad_perm:[0,1,2,3] row_mask:0x8 bank_mask:0xf
  v_mov_b32_dpp v69, v197 quad_perm:[0,1,2,3] row_mask:0x8 bank_mask:0xf
  buffer_store_dwordx4 v[68:71], v9, s[40:43], s46 offen sc1
  s_add_u32 s46, s46, 24576
  s_add_u32 s47, s47, 1
  s_cmp_lt_u32 s47, 5
  s_cbranch_scc1 L_f_blk
L_h_noffn:
  v_mov_b32 v8, 2
  s_mov_b64 exec, 1
  ds_write_b32 v7, v8
  s_mov_b64 exec, -1
  s_lshl_b32 s33, s26, 3
  s_add_u32 s33, s33, s27
  v_lshrrev_b32 v20, 5, v1
  v_mul_u32_u24 v20, 1280, v20
  v_and_b32 v21, 15, v1
  v_lshl_add_u32 v29, v21, 1, v20
  s_lshl_b32 s34, s33, 5
  v_lshlrev_b32 v109, 3, v1
  v_lshlrev_b32 v108, 7, v1
  s_and_b32 s23, s2, 7
  s_lshl_b32 s23, s23, 13
  s_add_u32 s23, s23, 1429504
  s_mov_b32 s19, 12
  s_load_dwordx2 s[14:15], s[0:1], 72
  s_waitcnt lgkmcnt(0)
  s_mov_b64 exec, 15
  s_mov_b32 s47, 3200000
L_lw33:
  ds_read_b32 v8, v7 offset:80
  s_waitcnt lgkmcnt(0)
  v_cmp_gt_u32 vcc, 0xc, v8
  s_cbranch_vccz L_lwd34
  s_sleep 2
  s_sub_u32 s47, s47, 1
  s_cbranch_scc0 L_lw33
L_lwd34:
  s_mov_b64 exec, -1
  s_add_u32 s46, s23, 0
  s_lshr_b32 s47, s2, 3
  s_lshl_b64 exec, 1, s47
  buffer_store_dwordx2 v[70:71], v108, s[40:43], s46 offen
  s_not_b32 exec_lo, exec_lo
  s_mov_b32 exec_hi, 1
  buffer_load_dwordx2 v[20:21], v108, s[40:43], s46 offen sc1
  s_waitcnt vmcnt(0)
  v_cmp_eq_u64 vcc, s[30:31], v[20:21]
  s_mov_b64 exec, 1
  s_bcnt1_i32_b32 s47, vcc_lo
  v_readlane_b32 s48, v20, 32
  v_readlane_b32 s49, v21, 32
  s_cmp_eq_u32 s49, s30
  s_cselect_b32 s19, s48, s19
  s_mov_b32 s48, s19
  s_add_u32 s48, s48, s47
  s_cmp_ge_u32 s48, 32
  s_cselect_b32 s49, 1, 0
  s_cmp_ge_u32 s48, 39
  s_cselect_b32 s49, 2, s49
  s_cmp_lt_u32 s48, 20
  s_cselect_b32 s49, 3, s49
  v_mov_b32 v8, s49
  ds_write_b32 v7, v8 offset:4
  s_sub_u32 s47, s47, 15
  s_cmp_lt_u32 s47, 2
  s_cbranch_scc0 L_md35
  s_and_b32 s48, s2, 7
  s_lshl_b32 s47, 1, s48
  s_atomic_or s47, s[14:15], 0 glc
  s_waitcnt lgkmcnt(0)
  s_bitcmp1_b32 s47, s48
  s_cbranch_scc1 L_md35
  s_bcnt1_i32_b32 s47, s47
  s_min_u32 s47, s47, 4
  s_mul_i32 s47, s47, 3
  v_mov_b32 v20, s47
  v_mov_b32 v21, s30
  s_add_u32 s46, s46, 4104
  buffer_store_dwordx2 v[20:21], v108, s[40:43], s46 offen
  s_waitcnt vmcnt(0)
L_md35:
  s_mov_b64 exec, -1
  s_mov_b64 exec, 15
  s_mov_b32 s47, 3200000
L_lw36:
  ds_read_b32 v8, v7 offset:80
  s_waitcnt lgkmcnt(0)
  v_cmp_gt_u32 vcc, 0x13, v8
  s_cbranch_vccz L_lwd37
  s_sleep 2
  s_sub_u32 s47, s47, 1
  s_cbranch_scc0 L_lw36
L_lwd37:
  s_mov_b64 exec, -1
  s_add_u32 s46, s23, 8
  s_lshr_b32 s47, s2, 3
  s_lshl_b64 exec, 1, s47
  buffer_store_dwordx2 v[70:71], v108, s[40:43], s46 offen
  s_not_b32 exec_lo, exec_lo
  s_mov_b32 exec_hi, 1
  buffer_load_dwordx2 v[20:21], v108, s[40:43], s46 offen sc1
  s_waitcnt vmcnt(0)
  v_cmp_eq_u64 vcc, s[30:31], v[20:21]
  s_mov_b64 exec, 1
  s_bcnt1_i32_b32 s47, vcc_lo
  v_readlane_b32 s48, v20, 32
  v_readlane_b32 s49, v21, 32
  s_cmp_eq_u32 s49, s30
  s_cselect_b32 s19, s48, s19
  s_mov_b32 s48, s19
  s_add_u32 s48, s48, s47
  s_cmp_ge_u32 s48, 32
  s_cselect_b32 s49, 1, 0
  s_cmp_ge_u32 s48, 39
  s_cselect_b32 s49, 2, s49
  s_cmp_lt_u32 s48, 20
  s_cselect_b32 s49, 3, s49
  v_mov_b32 v8, s49
  ds_write_b32 v7, v8 offset:4
  s_sub_u32 s47, s47, 15
  s_cmp_lt_u32 s47, 2
  s_cbranch_scc0 L_md38
  s_and_b32 s48, s2, 7
  s_lshl_b32 s47, 1, s48
  s_atomic_or s47, s[14:15], 4 glc
  s_waitcnt lgkmcnt(0)
  s_bitcmp1_b32 s47, s48
  s_cbranch_scc1 L_md38
  s_bcnt1_i32_b32 s47, s47
  s_min_u32 s47, s47, 4
  s_mul_i32 s47, s47, 3
  v_mov_b32 v20, s47
  v_mov_b32 v21, s30
  s_add_u32 s46, s46, 4104
  buffer_store_dwordx2 v[20:21], v108, s[40:43], s46 offen
  s_waitcnt vmcnt(0)
L_md38:
  s_mov_b64 exec, -1
  s_mov_b64 exec, 15
  s_mov_b32 s47, 3200000
L_lw39:
  ds_read_b32 v8, v7 offset:16
  s_waitcnt lgkmcnt(0)
  v_cmp_gt_u32 vcc, 0x1, v8
  s_cbranch_vccz L_lwd40
  s_sleep 4
  s_sub_u32 s47, s47, 1
  s_cbranch_scc0 L_lw39
L_lwd40:
  s_mov_b64 exec, -1
  v_add_u32 v8, 162048, v109
  s_lshl_b32 s29, s26, 10
  s_add_u32 s29, s29, 266240
  s_lshl_b32 s92, s27, 7
  s_add_u32 s92, s92, s29
  s_getreg_b32 s51, hwreg(HW_REG_XCC_ID, 0, 4)
  v_mov_b32 v239, s30
  v_mov_b32 v238, s51
  v_lshrrev_b32 v10, 2, v1
  v_lshlrev_b32 v10, 7, v10
  v_and_b32 v9, 3, v1
  v_lshl_add_u32 v10, v9, 4, v10
  s_mov_b64 exec, 15
  ds_read_b64 v[236:237], v8
  s_waitcnt lgkmcnt(0)
  s_cmp_eq_u32 s93, 0
  s_cbranch_scc0 L_pb41
  buffer_store_dwordx4 v[236:239], v66, s[40:43], s92 offen offset:0
L_pbd42:
  s_mov_b64 exec, -1
  s_mov_b64 exec, 15
  s_mov_b32 s47, 3200000
L_lw43:
  ds_read_b32 v8, v7 offset:80
  s_waitcnt lgkmcnt(0)
  v_cmp_gt_u32 vcc, 0x18, v8
  s_cbranch_vccz L_lwd44
  s_sleep 2
  s_sub_u32 s47, s47, 1
  s_cbranch_scc0 L_lw43
L_lwd44:
  s_mov_b64 exec, -1
  s_mov_b32 s48, 1
  s_mov_b32 s47, 400000
L_g45:
  s_mov_b32 exec_hi, 0
  buffer_load_dwordx4 v[72:75], v10, s[40:43], s29 offen offset:0 sc1
L_gs47:
  s_waitcnt vmcnt(0)
  v_cmp_ne_u32 vcc, s30, v75
  s_cbranch_vccnz L_gc48
  s_bitset0_b32 s48, 0
L_gc48:
  s_cmp_eq_u32 s48, 0
  s_cbranch_scc1 L_gd46
  s_sleep 8
  s_cmp_eq_u32 s47, 399976
  s_cbranch_scc0 L_gt49
  s_mov_b64 exec, -1
  s_mov_b32 s93, 1
  s_cmp_eq_u32 s95, 0
  s_cbranch_scc1 L_rq50
  buffer_store_dwordx4 v[232:235], v66, s[40:43], s94 offen sc1
  s_waitcnt vmcnt(0)
L_rq50:
  s_mov_b32 s93, 1
  s_mov_b64 exec, 15
  buffer_store_dwordx4 v[236:239], v66, s[40:43], s92 offen sc1
  s_mov_b64 exec, -1
  s_waitcnt vmcnt(0)
L_gt49:
  s_sub_u32 s47, s47, 1
  s_cbranch_scc0 L_g45
L_gd46:
  v_cmp_ne_u32 vcc, s51, v74
  s_cbranch_vccz L_h_same
  s_mov_b32 s93, 1
  s_mov_b64 exec, 15
  buffer_store_dwordx4 v[236:239], v66, s[40:43], s92 offen sc1
  s_mov_b64 exec, -1
  s_waitcnt vmcnt(0)
L_h_same:
  s_mov_b64 exec, -1
  v_mov_b32 v20, v72
  s_nop 1
  v_max_f32_dpp v20, v20, v20 quad_perm:[1,0,3,2] row_mask:0xf bank_mask:0xf
  s_nop 1
  v_max_f32_dpp v20, v20, v20 quad_perm:[2,3,0,1] row_mask:0xf bank_mask:0xf
  s_nop 1
  v_max_f32_dpp v20, v20, v20 row_half_mirror row_mask:0xf bank_mask:0xf
  s_nop 1
  v_max_f32_dpp v20, v20, v20 row_mirror row_mask:0xf bank_mask:0xf
  v_mov_b32 v21, v20
  s_nop 1
  v_permlane16_swap_b32 v20, v21
  v_max_f32 v20, v20, v21
  v_sub_f32 v20, v72, v20
  v_mul_f32 v20, 0x3fb8aa3b, v20
  v_exp_f32 v20, v20
  s_nop 0
  v_mul_f32 v22, v20, v73
  s_nop 1
  v_add_f32_dpp v22, v22, v22 quad_perm:[1,0,3,2] row_mask:0xf bank_mask:0xf
  s_nop 1
  v_add_f32_dpp v22, v22, v22 quad_perm:[2,3,0,1] row_mask:0xf bank_mask:0xf
  s_nop 1
  v_add_f32_dpp v22, v22, v22 row_half_mirror row_mask:0xf bank_mask:0xf
  s_nop 1
  v_add_f32_dpp v22, v22, v22 row_mirror row_mask:0xf bank_mask:0xf
  v_mov_b32 v21, v22
  s_nop 1
  v_permlane16_swap_b32 v22, v21
  v_add_f32 v22, v22, v21
  v_rcp_f32 v22, v22
  s_nop 0
  v_mul_f32 v20, v20, v22
  s_lshl_b32 s46, s27, 2
  v_readlane_b32 s4, v20, s46
  s_add_u32 s46, s46, 1
  v_readlane_b32 s5, v20, s46
  s_add_u32 s46, s46, 1
  v_readlane_b32 s6, v20, s46
  s_add_u32 s46, s46, 1
  v_readlane_b32 s7, v20, s46
  s_add_u32 s46, s46, 1
  s_mov_b64 exec, 15
  s_mov_b32 s47, 3200000
L_lw51:
  ds_read_b32 v8, v7 offset:80
  s_waitcnt lgkmcnt(0)
  v_cmp_gt_u32 vcc, 0x1a, v8
  s_cbranch_vccz L_lwd52
  s_sleep 2
  s_sub_u32 s47, s47, 1
  s_cbranch_scc0 L_lw51
L_lwd52:
  s_mov_b64 exec, -1
  s_add_u32 s46, s23, 16
  s_lshr_b32 s47, s2, 3
  s_lshl_b64 exec, 1, s47
  buffer_store_dwordx2 v[70:71], v108, s[40:43], s46 offen
  s_not_b32 exec_lo, exec_lo
  s_mov_b32 exec_hi, 1
  buffer_load_dwordx2 v[20:21], v108, s[40:43], s46 offen sc1
  s_waitcnt vmcnt(0)
  v_cmp_eq_u64 vcc, s[30:31], v[20:21]
  s_mov_b64 exec, 1
  s_bcnt1_i32_b32 s47, vcc_lo
  v_readlane_b32 s48, v20, 32
  v_readlane_b32 s49, v21, 32
  s_cmp_eq_u32 s49, s30
  s_cselect_b32 s19, s48, s19
  s_mov_b32 s48, s19
  s_add_u32 s48, s48, s47
  s_cmp_ge_u32 s48, 32
  s_cselect_b32 s49, 1, 0
  s_cmp_ge_u32 s48, 39
  s_cselect_b32 s49, 2, s49
  s_cmp_lt_u32 s48, 20
  s_cselect_b32 s49, 3, s49
  v_mov_b32 v8, s49
  ds_write_b32 v7, v8 offset:4
  s_sub_u32 s47, s47, 15
  s_cmp_lt_u32 s47, 2
  s_cbranch_scc0 L_md53
  s_and_b32 s48, s2, 7
  s_lshl_b32 s47, 1, s48
  s_atomic_or s47, s[14:15], 8 glc
  s_waitcnt lgkmcnt(0)
  s_bitcmp1_b32 s47, s48
  s_cbranch_scc1 L_md53
  s_bcnt1_i32_b32 s47, s47
  s_min_u32 s47, s47, 4
  s_mul_i32 s47, s47, 3
  v_mov_b32 v20, s47
  v_mov_b32 v21, s30
  s_add_u32 s46, s46, 4104
  buffer_store_dwordx2 v[20:21], v108, s[40:43], s46 offen
  s_waitcnt vmcnt(0)
L_md53:
  s_mov_b64 exec, -1
  s_mov_b64 exec, 15
  s_mov_b32 s47, 3200000
L_lw54:
  ds_read_b32 v8, v7 offset:80
  s_waitcnt lgkmcnt(0)
  v_cmp_gt_u32 vcc, 0x21, v8
  s_cbranch_vccz L_lwd55
  s_sleep 2
  s_sub_u32 s47, s47, 1
  s_cbranch_scc0 L_lw54
L_lwd55:
  s_mov_b64 exec, -1
  s_add_u32 s46, s23, 24
  s_lshr_b32 s47, s2, 3
  s_lshl_b64 exec, 1, s47
  buffer_store_dwordx2 v[70:71], v108, s[40:43], s46 offen
  s_not_b32 exec_lo, exec_lo
  s_mov_b32 exec_hi, 1
  buffer_load_dwordx2 v[20:21], v108, s[40:43], s46 offen sc1
  s_waitcnt vmcnt(0)
  v_cmp_eq_u64 vcc, s[30:31], v[20:21]
  s_mov_b64 exec, 1
  s_bcnt1_i32_b32 s47, vcc_lo
  v_readlane_b32 s48, v20, 32
  v_readlane_b32 s49, v21, 32
  s_cmp_eq_u32 s49, s30
  s_cselect_b32 s19, s48, s19
  s_mov_b32 s48, s19
  s_add_u32 s48, s48, s47
  s_cmp_ge_u32 s48, 32
  s_cselect_b32 s49, 1, 0
  s_cmp_ge_u32 s48, 39
  s_cselect_b32 s49, 2, s49
  s_cmp_lt_u32 s48, 20
  s_cselect_b32 s49, 3, s49
  v_mov_b32 v8, s49
  ds_write_b32 v7, v8 offset:4
  s_sub_u32 s47, s47, 15
  s_cmp_lt_u32 s47, 2
  s_cbranch_scc0 L_md56
  s_and_b32 s48, s2, 7
  s_lshl_b32 s47, 1, s48
  s_atomic_or s47, s[14:15], 12 glc
  s_waitcnt lgkmcnt(0)
  s_bitcmp1_b32 s47, s48
  s_cbranch_scc1 L_md56
  s_bcnt1_i32_b32 s47, s47
  s_min_u32 s47, s47, 4
  s_mul_i32 s47, s47, 3
  v_mov_b32 v20, s47
  v_mov_b32 v21, s30
  s_add_u32 s46, s46, 4104
  buffer_store_dwordx2 v[20:21], v108, s[40:43], s46 offen
  s_waitcnt vmcnt(0)
L_md56:
  s_mov_b64 exec, -1
  s_mov_b64 exec, 15
  s_mov_b32 s47, 3200000
L_lw57:
  ds_read_b32 v8, v7 offset:80
  s_waitcnt lgkmcnt(0)
  v_cmp_gt_u32 vcc, 0x24, v8
  s_cbranch_vccz L_lwd58
  s_sleep 2
  s_sub_u32 s47, s47, 1
  s_cbranch_scc0 L_lw57
L_lwd58:
  s_mov_b64 exec, -1
  v_add_u32 v24, 151552, v110
  v_add_u32 v25, 153088, v110
  v_add_u32 v26, 154624, v110
  v_add_u32 v27, 156160, v110
  s_add_u32 s18, s31, 1
  v_mov_b32 v35, s18
  s_mov_b32 s35, s94
  s_add_u32 s29, s44, 4096
  s_add_u32 s46, s27, 1
  s_and_b32 s46, s46, 7
  s_lshl_b32 s46, s46, 10
  s_add_u32 s52, s46, s29
  s_add_u32 s46, s27, 2
  s_and_b32 s46, s46, 7
  s_lshl_b32 s46, s46, 10
  s_add_u32 s53, s46, s29
  s_add_u32 s46, s27, 3
  s_and_b32 s46, s46, 7
  s_lshl_b32 s46, s46, 10
  s_add_u32 s54, s46, s29
  s_add_u32 s46, s27, 4
  s_and_b32 s46, s46, 7
  s_lshl_b32 s46, s46, 10
  s_add_u32 s55, s46, s29
  s_add_u32 s46, s27, 5
  s_and_b32 s46, s46, 7
  s_lshl_b32 s46, s46, 10
  s_add_u32 s56, s46, s29
  s_add_u32 s46, s27, 6
  s_and_b32 s46, s46, 7
  s_lshl_b32 s46, s46, 10
  s_add_u32 s57, s46, s29
  s_add_u32 s46, s27, 7
  s_and_b32 s46, s46, 7
  s_lshl_b32 s46, s46, 10
  s_add_u32 s58, s46, s29
  v_and_b32 v28, 35, v1
  v_bfe_u32 v20, v1, 2, 2
  v_lshl_or_b32 v28, v20, 3, v28
  v_bfe_u32 v20, v1, 4, 1
  v_lshl_or_b32 v28, v20, 2, v28
  v_lshlrev_b32 v28, 1, v28
  v_add_u32 v28, 161024, v28
  s_mov_b32 s32, 0
  s_branch L_h_b
L_h_bar:
  s_barrier
L_tail:
L_h_b:
  ds_read2st64_b32 v[36:37], v24 offset0:0 offset1:1
  ds_read2st64_b32 v[38:39], v24 offset0:2 offset1:3
  ds_read2st64_b32 v[40:41], v24 offset0:4 offset1:5
  ds_read2st64_b32 v[42:43], v25 offset0:0 offset1:1
  ds_read2st64_b32 v[44:45], v25 offset0:2 offset1:3
  ds_read2st64_b32 v[46:47], v25 offset0:4 offset1:5
  ds_read2st64_b32 v[48:49], v26 offset0:0 offset1:1
  ds_read2st64_b32 v[50:51], v26 offset0:2 offset1:3
  ds_read2st64_b32 v[52:53], v26 offset0:4 offset1:5
  ds_read2st64_b32 v[54:55], v27 offset0:0 offset1:1
  ds_read2st64_b32 v[56:57], v27 offset0:2 offset1:3
  ds_read2st64_b32 v[58:59], v27 offset0:4 offset1:5
  s_waitcnt lgkmcnt(9)
  v_add_f32 v36, v36, v39
  v_add_f32 v37, v37, v40
  v_add_f32 v38, v38, v41
  v_mul_f32 v32, s4, v36
  v_mul_f32 v33, s4, v37
  v_mul_f32 v34, s4, v38
  s_waitcnt lgkmcnt(6)
  v_add_f32 v42, v42, v45
  v_add_f32 v43, v43, v46
  v_add_f32 v44, v44, v47
  v_fmac_f32 v32, s5, v42
  v_fmac_f32 v33, s5, v43
  v_fmac_f32 v34, s5, v44
  s_waitcnt lgkmcnt(3)
  v_add_f32 v48, v48, v51
  v_add_f32 v49, v49, v52
  v_add_f32 v50, v50, v53
  v_fmac_f32 v32, s6, v48
  v_fmac_f32 v33, s6, v49
  v_fmac_f32 v34, s6, v50
  s_waitcnt lgkmcnt(0)
  v_add_f32 v54, v54, v57
  v_add_f32 v55, v55, v58
  v_add_f32 v56, v56, v59
  v_fmac_f32 v32, s7, v54
  v_fmac_f32 v33, s7, v55
  v_fmac_f32 v34, s7, v56
  s_cmp_eq_u32 s93, 0
  s_cbranch_scc0 L_pb59
  buffer_store_dwordx4 v[32:35], v66, s[40:43], s35 offen offset:0
L_pbd60:
  s_cmp_eq_u32 s32, 0
  s_cbranch_scc1 L_h_lazy0
L_h_g7:
  s_mov_b32 s47, 400000
  s_mov_b32 s48, s18
  s_mov_b32 s49, s18
  buffer_load_dwordx4 v[112:115], v66, s[40:43], s52 offen offset:0 sc1
  buffer_load_dwordx4 v[116:119], v66, s[40:43], s53 offen offset:0 sc1
  buffer_load_dwordx4 v[120:123], v66, s[40:43], s54 offen offset:0 sc1
  buffer_load_dwordx4 v[124:127], v66, s[40:43], s55 offen offset:0 sc1
  buffer_load_dwordx4 v[128:131], v66, s[40:43], s56 offen offset:0 sc1
  buffer_load_dwordx4 v[132:135], v66, s[40:43], s57 offen offset:0 sc1
  buffer_load_dwordx4 v[136:139], v66, s[40:43], s58 offen offset:0 sc1
L_pg61:
  buffer_load_dwordx4 v[140:143], v66, s[40:43], s52 offen offset:0 sc1
  buffer_load_dwordx4 v[144:147], v66, s[40:43], s53 offen offset:0 sc1
  buffer_load_dwordx4 v[148:151], v66, s[40:43], s54 offen offset:0 sc1
  buffer_load_dwordx4 v[152:155], v66, s[40:43], s55 offen offset:0 sc1
  buffer_load_dwordx4 v[156:159], v66, s[40:43], s56 offen offset:0 sc1
  buffer_load_dwordx4 v[160:163], v66, s[40:43], s57 offen offset:0 sc1
  buffer_load_dwordx4 v[164:167], v66, s[40:43], s58 offen offset:0 sc1
  s_waitcnt vmcnt(7)
  v_min3_u32 v12, v115, v119, v123
  v_max3_u32 v13, v115, v119, v123
  v_min3_u32 v12, v12, v127, v131
  v_max3_u32 v13, v13, v127, v131
  v_min3_u32 v12, v12, v135, v139
  v_max3_u32 v13, v13, v135, v139
  v_cmp_ne_u64 vcc, s[48:49], v[12:13]
  v_pk_add_f32 v[36:37], v[32:33], v[136:137]
  v_add_f32 v38, v34, v138
  v_pk_add_f32 v[40:41], v[112:113], v[116:117]
  v_add_f32 v42, v114, v118
  v_pk_add_f32 v[44:45], v[120:121], v[124:125]
  v_add_f32 v46, v122, v126
  v_pk_add_f32 v[48:49], v[128:129], v[132:133]
  v_add_f32 v50, v130, v134
  s_cbranch_vccz L_o_sum
  buffer_load_dwordx4 v[112:115], v66, s[40:43], s52 offen offset:0 sc1
  buffer_load_dwordx4 v[116:119], v66, s[40:43], s53 offen offset:0 sc1
  buffer_load_dwordx4 v[120:123], v66, s[40:43], s54 offen offset:0 sc1
  buffer_load_dwordx4 v[124:127], v66, s[40:43], s55 offen offset:0 sc1
  buffer_load_dwordx4 v[128:131], v66, s[40:43], s56 offen offset:0 sc1
  buffer_load_dwordx4 v[132:135], v66, s[40:43], s57 offen offset:0 sc1
  buffer_load_dwordx4 v[136:139], v66, s[40:43], s58 offen offset:0 sc1
  s_waitcnt vmcnt(7)
  v_min3_u32 v12, v143, v147, v151
  v_max3_u32 v13, v143, v147, v151
  v_min3_u32 v12, v12, v155, v159
  v_max3_u32 v13, v13, v155, v159
  v_min3_u32 v12, v12, v163, v167
  v_max3_u32 v13, v13, v163, v167
  v_cmp_ne_u64 vcc, s[48:49], v[12:13]
  v_pk_add_f32 v[36:37], v[32:33], v[164:165]
  v_add_f32 v38, v34, v166
  v_pk_add_f32 v[40:41], v[140:141], v[144:145]
  v_add_f32 v42, v142, v146
  v_pk_add_f32 v[44:45], v[148:149], v[152:153]
  v_add_f32 v46, v150, v154
  v_pk_add_f32 v[48:49], v[156:157], v[160:161]
  v_add_f32 v50, v158, v162
  s_cbranch_vccz L_o_sum
  s_sub_u32 s47, s47, 1
  s_cbranch_scc0 L_pg61
L_o_sum:
  v_pk_add_f32 v[36:37], v[36:37], v[48:49]
  v_add_f32 v38, v38, v50
  v_pk_add_f32 v[40:41], v[40:41], v[44:45]
  v_add_f32 v42, v42, v46
  v_pk_add_f32 v[40:41], v[40:41], v[36:37]
  v_add_f32 v42, v42, v38
  v_cvt_pk_bf16_f32 v40, v40, v41
  v_cvt_pk_bf16_f32 v42, v42, v42
  ds_write_b16 v28, v40
  ds_write_b16_d16_hi v28, v40 offset:128
  ds_write_b16 v28, v42 offset:256
  s_cmp_eq_u32 s32, 0
  s_cbranch_scc1 L_h_next1
  ds_read_b128 v[196:199], v105 offset:0
  ds_read_b128 v[200:203], v105 offset:64
  ds_read_b128 v[204:207], v105 offset:128
  ds_read_b128 v[208:211], v105 offset:192
  ds_read_b128 v[212:215], v105 offset:256
  ds_read_b128 v[216:219], v105 offset:320
  s_waitcnt lgkmcnt(6)
  s_barrier
  ds_read_b64_tr_b16 v[172:173], v104 offset:0
  ds_read_b64_tr_b16 v[174:175], v104 offset:2560
  ds_read_b64_tr_b16 v[176:177], v104 offset:5120
  ds_read_b64_tr_b16 v[178:179], v104 offset:7680
  ds_read_b64_tr_b16 v[180:181], v104 offset:10240
  ds_read_b64_tr_b16 v[182:183], v104 offset:12800
  ds_read_b64_tr_b16 v[184:185], v104 offset:15360
  ds_read_b64_tr_b16 v[186:187], v104 offset:17920
  ds_read_b64_tr_b16 v[188:189], v104 offset:20480
  ds_read_b64_tr_b16 v[190:191], v104 offset:23040
  ds_read_b64_tr_b16 v[192:193], v104 offset:25600
  ds_read_b64_tr_b16 v[194:195], v104 offset:28160
  s_waitcnt lgkmcnt(10)
  v_mfma_f32_16x16x32_bf16 v[220:223], v[196:199], v[172:175], 0
  s_waitcnt lgkmcnt(8)
  v_mfma_f32_16x16x32_bf16 v[224:227], v[200:203], v[176:179], 0
  s_waitcnt lgkmcnt(6)
  v_mfma_f32_16x16x32_bf16 v[220:223], v[204:207], v[180:183], v[220:223]
  s_waitcnt lgkmcnt(4)
  v_mfma_f32_16x16x32_bf16 v[224:227], v[208:211], v[184:187], v[224:227]
  s_waitcnt lgkmcnt(2)
  v_mfma_f32_16x16x32_bf16 v[220:223], v[212:215], v[188:191], v[220:223]
  s_waitcnt lgkmcnt(0)
  v_mfma_f32_16x16x32_bf16 v[224:227], v[216:219], v[192:195], v[224:227]
  s_mov_b64 exec, 0xffff
  s_nop 6
  v_pk_add_f32 v[68:69], v[220:221], v[224:225]
  buffer_store_dwordx4 v[68:71], v66, s[40:43], s60 offen sc1
  s_mov_b64 exec, -1
  s_cmp_eq_u32 s61, 0
  s_cbranch_scc1 L_fin
  s_mov_b32 s47, 400000
  s_mov_b32 s48, s31
  s_mov_b32 s49, s31
  buffer_load_dwordx4 v[72:75], v66, s[40:43], s62 offen offset:0 sc1
  buffer_load_dwordx4 v[76:79], v66, s[40:43], s62 offen offset:1024 sc1
  buffer_load_dwordx4 v[80:83], v66, s[40:43], s62 offen offset:2048 sc1
  buffer_load_dwordx4 v[84:87], v66, s[40:43], s62 offen offset:3072 sc1
  buffer_load_dwordx4 v[88:91], v66, s[40:43], s63 offen offset:0 sc1
  buffer_load_dwordx4 v[92:95], v66, s[40:43], s63 offen offset:1024 sc1
  buffer_load_dwordx4 v[96:99], v66, s[40:43], s63 offen offset:2048 sc1
  buffer_load_dwordx4 v[100:103], v66, s[40:43], s63 offen offset:3072 sc1
L_pg62:
  buffer_load_dwordx4 v[104:107], v66, s[40:43], s62 offen offset:0 sc1
  buffer_load_dwordx4 v[108:111], v66, s[40:43], s62 offen offset:1024 sc1
  buffer_load_dwordx4 v[112:115], v66, s[40:43], s62 offen offset:2048 sc1
  buffer_load_dwordx4 v[116:119], v66, s[40:43], s62 offen offset:3072 sc1
  buffer_load_dwordx4 v[120:123], v66, s[40:43], s63 offen offset:0 sc1
  buffer_load_dwordx4 v[124:127], v66, s[40:43], s63 offen offset:1024 sc1
  buffer_load_dwordx4 v[128:131], v66, s[40:43], s63 offen offset:2048 sc1
  buffer_load_dwordx4 v[132:135], v66, s[40:43], s63 offen offset:3072 sc1
  s_waitcnt vmcnt(8)
  v_min3_u32 v12, v75, v79, v83
  v_max3_u32 v13, v75, v79, v83
  v_min3_u32 v12, v12, v87, v91
  v_max3_u32 v13, v13, v87, v91
  v_min3_u32 v12, v12, v95, v99
  v_max3_u32 v13, v13, v95, v99
  v_min_u32 v12, v12, v103
  v_max_u32 v13, v13, v103
  v_cmp_ne_u64 vcc, s[48:49], v[12:13]
  v_pk_add_f32 v[20:21], v[72:73], v[76:77]
  v_pk_add_f32 v[22:23], v[80:81], v[84:85]
  v_pk_add_f32 v[20:21], v[20:21], v[88:89]
  v_pk_add_f32 v[22:23], v[22:23], v[92:93]
  v_pk_add_f32 v[20:21], v[20:21], v[96:97]
  v_pk_add_f32 v[22:23], v[22:23], v[100:101]
  s_cbranch_vccz L_y_sum
  buffer_load_dwordx4 v[72:75], v66, s[40:43], s62 offen offset:0 sc1
  buffer_load_dwordx4 v[76:79], v66, s[40:43], s62 offen offset:1024 sc1
  buffer_load_dwordx4 v[80:83], v66, s[40:43], s62 offen offset:2048 sc1
  buffer_load_dwordx4 v[84:87], v66, s[40:43], s62 offen offset:3072 sc1
  buffer_load_dwordx4 v[88:91], v66, s[40:43], s63 offen offset:0 sc1
  buffer_load_dwordx4 v[92:95], v66, s[40:43], s63 offen offset:1024 sc1
  buffer_load_dwordx4 v[96:99], v66, s[40:43], s63 offen offset:2048 sc1
  buffer_load_dwordx4 v[100:103], v66, s[40:43], s63 offen offset:3072 sc1
  s_waitcnt vmcnt(8)
  v_min3_u32 v12, v107, v111, v115
  v_max3_u32 v13, v107, v111, v115
  v_min3_u32 v12, v12, v119, v123
  v_max3_u32 v13, v13, v119, v123
  v_min3_u32 v12, v12, v127, v131
  v_max3_u32 v13, v13, v127, v131
  v_min_u32 v12, v12, v135
  v_max_u32 v13, v13, v135
  v_cmp_ne_u64 vcc, s[48:49], v[12:13]
  v_pk_add_f32 v[20:21], v[104:105], v[108:109]
  v_pk_add_f32 v[22:23], v[112:113], v[116:117]
  v_pk_add_f32 v[20:21], v[20:21], v[120:121]
  v_pk_add_f32 v[22:23], v[22:23], v[124:125]
  v_pk_add_f32 v[20:21], v[20:21], v[128:129]
  v_pk_add_f32 v[22:23], v[22:23], v[132:133]
  s_cbranch_vccz L_y_sum
  s_sub_u32 s47, s47, 1
  s_cbranch_scc0 L_pg62
L_y_sum:
  v_pk_add_f32 v[20:21], v[20:21], v[22:23]
  s_nop 1
  v_permlane32_swap_b32 v20, v21
  v_add_f32 v20, v20, v21
  v_mov_b32 v21, v20
  s_nop 1
  v_permlane16_swap_b32 v20, v21
  v_add_f32 v20, v20, v21
  v_cvt_pk_bf16_f32 v20, 0, v20
  s_mov_b64 exec, s[14:15]
  v_mul_f32 v20, v20, v31
  v_cvt_pk_bf16_f32 v20, 0, v20
  v_add_f32 v20, v20, v30
  v_cvt_pk_bf16_f32 v20, v20, v20
  buffer_store_short v20, v29, s[96:99], s34 offen
  s_cmp_eq_u32 s33, 0
  s_cbranch_scc0 L_fin
  s_mov_b64 exec, 1
  s_mov_b32 s46, 1527808
  buffer_store_dwordx2 v[16:17], v66, s[40:43], 0 offen
  buffer_store_dwordx2 v[18:19], v66, s[40:43], s46 offen
L_fin:
  s_endpgm
L_sub_red:
  s_mov_b32 s47, 400000
L_g63:
  s_bitcmp1_b32 s48, 0
  s_cbranch_scc0 L_gs65
  buffer_load_dwordx4 v[72:75], v66, s[40:43], s62 offen offset:0 sc1
L_gs65:
  s_bitcmp1_b32 s48, 1
  s_cbranch_scc0 L_gs66
  buffer_load_dwordx4 v[76:79], v66, s[40:43], s62 offen offset:1024 sc1
L_gs66:
  s_bitcmp1_b32 s48, 2
  s_cbranch_scc0 L_gs67
  buffer_load_dwordx4 v[80:83], v66, s[40:43], s62 offen offset:2048 sc1
L_gs67:
  s_bitcmp1_b32 s48, 3
  s_cbranch_scc0 L_gs68
  buffer_load_dwordx4 v[84:87], v66, s[40:43], s62 offen offset:3072 sc1
L_gs68:
  s_bitcmp1_b32 s48, 4
  s_cbranch_scc0 L_gs69
  buffer_load_dwordx4 v[88:91], v66, s[40:43], s63 offen offset:0 sc1
L_gs69:
  s_bitcmp1_b32 s48, 5
  s_cbranch_scc0 L_gs70
  buffer_load_dwordx4 v[92:95], v66, s[40:43], s63 offen offset:1024 sc1
L_gs70:
  s_bitcmp1_b32 s48, 6
  s_cbranch_scc0 L_gs71
  buffer_load_dwordx4 v[96:99], v66, s[40:43], s63 offen offset:2048 sc1
L_gs71:
  s_bitcmp1_b32 s48, 7
  s_cbranch_scc0 L_gs72
  buffer_load_dwordx4 v[100:103], v66, s[40:43], s63 offen offset:3072 sc1
L_gs72:
  s_waitcnt vmcnt(0)
  v_cmp_ne_u64 vcc, s[30:31], v[74:75]
  s_cbranch_vccnz L_gc73
  s_bitset0_b32 s48, 0
L_gc73:
  v_cmp_ne_u64 vcc, s[30:31], v[78:79]
  s_cbranch_vccnz L_gc74
  s_bitset0_b32 s48, 1
L_gc74:
  v_cmp_ne_u64 vcc, s[30:31], v[82:83]
  s_cbranch_vccnz L_gc75
  s_bitset0_b32 s48, 2
L_gc75:
  v_cmp_ne_u64 vcc, s[30:31], v[86:87]
  s_cbranch_vccnz L_gc76
  s_bitset0_b32 s48, 3
L_gc76:
  v_cmp_ne_u64 vcc, s[30:31], v[90:91]
  s_cbranch_vccnz L_gc77
  s_bitset0_b32 s48, 4
L_gc77:
  v_cmp_ne_u64 vcc, s[30:31], v[94:95]
  s_cbranch_vccnz L_gc78
  s_bitset0_b32 s48, 5
L_gc78:
  v_cmp_ne_u64 vcc, s[30:31], v[98:99]
  s_cbranch_vccnz L_gc79
  s_bitset0_b32 s48, 6
L_gc79:
  v_cmp_ne_u64 vcc, s[30:31], v[102:103]
  s_cbranch_vccnz L_gc80
  s_bitset0_b32 s48, 7
L_gc80:
  s_cmp_eq_u32 s48, 0
  s_cbranch_scc1 L_gd64
  s_sub_u32 s47, s47, 1
  s_cbranch_scc0 L_g63
L_gd64:
  v_pk_add_f32 v[20:21], v[72:73], v[76:77]
  v_pk_add_f32 v[22:23], v[80:81], v[84:85]
  v_pk_add_f32 v[20:21], v[20:21], v[88:89]
  v_pk_add_f32 v[22:23], v[22:23], v[92:93]
  v_pk_add_f32 v[20:21], v[20:21], v[96:97]
  v_pk_add_f32 v[22:23], v[22:23], v[100:101]
  v_pk_add_f32 v[20:21], v[20:21], v[22:23]
  s_nop 1
  v_permlane32_swap_b32 v20, v21
  v_add_f32 v20, v20, v21
  v_mov_b32 v21, v20
  s_nop 1
  v_permlane16_swap_b32 v20, v21
  v_add_f32 v20, v20, v21
  v_cvt_pk_bf16_f32 v20, v20, v20
  v_lshlrev_b32 v20, 16, v20
  s_setpc_b64 s[16:17]
L_tail_end:
L_h_lazy0:
  s_mov_b64 exec, 15
  s_mov_b32 s47, 3200000
L_lw81:
  ds_read_b32 v8, v7 offset:80
  s_waitcnt lgkmcnt(0)
  v_cmp_gt_u32 vcc, 0x28, v8
  s_cbranch_vccz L_lwd82
  s_sleep 2
  s_sub_u32 s47, s47, 1
  s_cbranch_scc0 L_lw81
L_lwd82:
  s_mov_b64 exec, -1
  s_add_u32 s46, s23, 32
  s_lshr_b32 s47, s2, 3
  s_lshl_b64 exec, 1, s47
  buffer_store_dwordx2 v[70:71], v108, s[40:43], s46 offen
  s_not_b32 exec_lo, exec_lo
  s_mov_b32 exec_hi, 1
  buffer_load_dwordx2 v[20:21], v108, s[40:43], s46 offen sc1
  s_waitcnt vmcnt(0)
  v_cmp_eq_u64 vcc, s[30:31], v[20:21]
  s_mov_b64 exec, 1
  s_bcnt1_i32_b32 s47, vcc_lo
  v_readlane_b32 s48, v20, 32
  v_readlane_b32 s49, v21, 32
  s_cmp_eq_u32 s49, s30
  s_cselect_b32 s19, s48, s19
  s_mov_b32 s48, s19
  s_add_u32 s48, s48, s47
  s_cmp_ge_u32 s48, 32
  s_cselect_b32 s49, 1, 0
  s_cmp_ge_u32 s48, 39
  s_cselect_b32 s49, 2, s49
  s_cmp_lt_u32 s48, 20
  s_cselect_b32 s49, 3, s49
  v_mov_b32 v8, s49
  ds_write_b32 v7, v8 offset:4
  s_sub_u32 s47, s47, 15
  s_cmp_lt_u32 s47, 2
  s_cbranch_scc0 L_md83
  s_and_b32 s48, s2, 7
  s_lshl_b32 s47, 1, s48
  s_atomic_or s47, s[14:15], 16 glc
  s_waitcnt lgkmcnt(0)
  s_bitcmp1_b32 s47, s48
  s_cbranch_scc1 L_md83
  s_bcnt1_i32_b32 s47, s47
  s_min_u32 s47, s47, 4
  s_mul_i32 s47, s47, 3
  v_mov_b32 v20, s47
  v_mov_b32 v21, s30
  s_add_u32 s46, s46, 4104
  buffer_store_dwordx2 v[20:21], v108, s[40:43], s46 offen
  s_waitcnt vmcnt(0)
L_md83:
  s_mov_b64 exec, -1
  s_mov_b64 exec, 15
  s_mov_b32 s47, 3200000
L_lw84:
  ds_read_b32 v8, v7 offset:80
  s_waitcnt lgkmcnt(0)
  v_cmp_gt_u32 vcc, 0x29, v8
  s_cbranch_vccz L_lwd85
  s_sleep 2
  s_sub_u32 s47, s47, 1
  s_cbranch_scc0 L_lw84
L_lwd85:
  s_mov_b64 exec, -1
  s_branch L_h_g7
L_h_next1:
  s_cmp_lt_u32 s26, 5
  s_cbranch_scc0 L_h_nog
  s_mov_b64 exec, 15
  s_mov_b32 s47, 3200000
L_lw86:
  ds_read_b32 v8, v7 offset:80
  s_waitcnt lgkmcnt(0)
  v_cmp_gt_u32 vcc, 0x2c, v8
  s_cbranch_vccz L_lwd87
  s_sleep 2
  s_sub_u32 s47, s47, 1
  s_cbranch_scc0 L_lw86
L_lwd87:
  s_mov_b64 exec, -1
  buffer_load_ushort v30, v29, s[96:99], s34 offen
  s_mul_i32 s62, s33, 6144
  s_add_u32 s62, s62, 856064
  s_add_u32 s63, s62, 4096
  v_mov_b32 v96, 0
  v_mov_b32 v97, 0
  v_mov_b32 v100, 0
  v_mov_b32 v101, 0
  s_mov_b32 s48, 0x3f
  s_call_b64 s[16:17], L_sub_red
  v_mul_f32 v21, 0xbfb8aa3b, v20
  v_exp_f32 v21, v21
  s_nop 0
  v_add_f32 v21, 1.0, v21
  v_rcp_f32 v21, v21
  s_nop 0
  v_mul_f32 v21, v20, v21
  v_cvt_pk_bf16_f32 v21, v21, v21
  v_lshlrev_b32 v31, 16, v21
  v_lshlrev_b32 v30, 16, v30
L_h_nog:
  s_mov_b64 exec, 15
  s_mov_b32 s47, 3200000
L_lw88:
  ds_read_b32 v8, v7 offset:80
  s_waitcnt lgkmcnt(0)
  v_cmp_gt_u32 vcc, 0x2f, v8
  s_cbranch_vccz L_lwd89
  s_sleep 2
  s_sub_u32 s47, s47, 1
  s_cbranch_scc0 L_lw88
L_lwd89:
  s_mov_b64 exec, -1
  s_add_u32 s46, s23, 40
  s_lshr_b32 s47, s2, 3
  s_lshl_b64 exec, 1, s47
  buffer_store_dwordx2 v[70:71], v108, s[40:43], s46 offen
  s_not_b32 exec_lo, exec_lo
  s_mov_b32 exec_hi, 1
  buffer_load_dwordx2 v[20:21], v108, s[40:43], s46 offen sc1
  s_waitcnt vmcnt(0)
  v_cmp_eq_u64 vcc, s[30:31], v[20:21]
  s_mov_b64 exec, 1
  s_bcnt1_i32_b32 s47, vcc_lo
  v_readlane_b32 s48, v20, 32
  v_readlane_b32 s49, v21, 32
  s_cmp_eq_u32 s49, s30
  s_cselect_b32 s19, s48, s19
  s_mov_b32 s48, s19
  s_add_u32 s48, s48, s47
  s_cmp_ge_u32 s48, 32
  s_cselect_b32 s49, 1, 0
  s_cmp_ge_u32 s48, 39
  s_cselect_b32 s49, 2, s49
  s_cmp_lt_u32 s48, 20
  s_cselect_b32 s49, 3, s49
  v_mov_b32 v8, s49
  ds_write_b32 v7, v8 offset:4
  s_sub_u32 s47, s47, 15
  s_cmp_lt_u32 s47, 2
  s_cbranch_scc0 L_md90
  s_and_b32 s48, s2, 7
  s_lshl_b32 s47, 1, s48
  s_atomic_or s47, s[14:15], 20 glc
  s_waitcnt lgkmcnt(0)
  s_bitcmp1_b32 s47, s48
  s_cbranch_scc1 L_md90
  s_bcnt1_i32_b32 s47, s47
  s_min_u32 s47, s47, 4
  s_mul_i32 s47, s47, 3
  v_mov_b32 v20, s47
  v_mov_b32 v21, s30
  s_add_u32 s46, s46, 4104
  buffer_store_dwordx2 v[20:21], v108, s[40:43], s46 offen
  s_waitcnt vmcnt(0)
L_md90:
  s_mov_b64 exec, -1
  s_mov_b64 exec, 15
  s_mov_b32 s47, 3200000
L_lw91:
  ds_read_b32 v8, v7 offset:32
  s_waitcnt lgkmcnt(0)
  v_cmp_gt_u32 vcc, 0x1, v8
  s_cbranch_vccz L_lwd92
  s_sleep 4
  s_sub_u32 s47, s47, 1
  s_cbranch_scc0 L_lw91
L_lwd92:
  s_mov_b64 exec, -1
  v_add_u32 v8, 162080, v109
  s_lshl_b32 s29, s26, 10
  s_add_u32 s29, s29, 266304
  s_lshl_b32 s92, s27, 7
  s_add_u32 s92, s92, s29
  s_mov_b64 exec, 15
  ds_read_b64 v[236:237], v8
  s_waitcnt lgkmcnt(0)
  s_cmp_eq_u32 s93, 0
  s_cbranch_scc0 L_pb93
  buffer_store_dwordx4 v[236:239], v66, s[40:43], s92 offen offset:0
L_pbd94:
  s_mov_b64 exec, -1
  s_mov_b64 exec, 15
  s_mov_b32 s47, 3200000
L_lw95:
  ds_read_b32 v8, v7 offset:80
  s_waitcnt lgkmcnt(0)
  v_cmp_gt_u32 vcc, 0x35, v8
  s_cbranch_vccz L_lwd96
  s_sleep 2
  s_sub_u32 s47, s47, 1
  s_cbranch_scc0 L_lw95
L_lwd96:
  s_mov_b64 exec, -1
  s_add_u32 s46, s23, 48
  s_lshr_b32 s47, s2, 3
  s_lshl_b64 exec, 1, s47
  buffer_store_dwordx2 v[70:71], v108, s[40:43], s46 offen
  s_not_b32 exec_lo, exec_lo
  s_mov_b32 exec_hi, 1
  buffer_load_dwordx2 v[20:21], v108, s[40:43], s46 offen sc1
  s_waitcnt vmcnt(0)
  v_cmp_eq_u64 vcc, s[30:31], v[20:21]
  s_mov_b64 exec, 1
  s_bcnt1_i32_b32 s47, vcc_lo
  v_readlane_b32 s48, v20, 32
  v_readlane_b32 s49, v21, 32
  s_cmp_eq_u32 s49, s30
  s_cselect_b32 s19, s48, s19
  s_mov_b32 s48, s19
  s_add_u32 s48, s48, s47
  s_cmp_ge_u32 s48, 32
  s_cselect_b32 s49, 1, 0
  s_cmp_ge_u32 s48, 39
  s_cselect_b32 s49, 2, s49
  s_cmp_lt_u32 s48, 20
  s_cselect_b32 s49, 3, s49
  v_mov_b32 v8, s49
  ds_write_b32 v7, v8 offset:4
  s_mov_b64 exec, -1
  s_mov_b64 exec, 15
  s_mov_b32 s47, 3200000
L_lw97:
  ds_read_b32 v8, v7 offset:80
  s_waitcnt lgkmcnt(0)
  v_cmp_gt_u32 vcc, 0x37, v8
  s_cbranch_vccz L_lwd98
  s_sleep 2
  s_sub_u32 s47, s47, 1
  s_cbranch_scc0 L_lw97
L_lwd98:
  s_mov_b64 exec, -1
  s_mov_b32 s48, 1
  s_mov_b32 s47, 400000
L_g99:
  s_mov_b32 exec_hi, 0
  buffer_load_dwordx4 v[72:75], v10, s[40:43], s29 offen offset:0 sc1
L_gs101:
  s_waitcnt vmcnt(0)
  v_cmp_ne_u32 vcc, s30, v75
  s_cbranch_vccnz L_gc102
  s_bitset0_b32 s48, 0
L_gc102:
  s_cmp_eq_u32 s48, 0
  s_cbranch_scc1 L_gd100
  s_sleep 8
  s_sub_u32 s47, s47, 1
  s_cbranch_scc0 L_g99
L_gd100:
  s_mov_b64 exec, -1
  v_mov_b32 v20, v72
  s_nop 1
  v_max_f32_dpp v20, v20, v20 quad_perm:[1,0,3,2] row_mask:0xf bank_mask:0xf
  s_nop 1
  v_max_f32_dpp v20, v20, v20 quad_perm:[2,3,0,1] row_mask:0xf bank_mask:0xf
  s_nop 1
  v_max_f32_dpp v20, v20, v20 row_half_mirror row_mask:0xf bank_mask:0xf
  s_nop 1
  v_max_f32_dpp v20, v20, v20 row_mirror row_mask:0xf bank_mask:0xf
  v_mov_b32 v21, v20
  s_nop 1
  v_permlane16_swap_b32 v20, v21
  v_max_f32 v20, v20, v21
  v_sub_f32 v20, v72, v20
  v_mul_f32 v20, 0x3fb8aa3b, v20
  v_exp_f32 v20, v20
  s_nop 0
  v_mul_f32 v22, v20, v73
  s_nop 1
  v_add_f32_dpp v22, v22, v22 quad_perm:[1,0,3,2] row_mask:0xf bank_mask:0xf
  s_nop 1
  v_add_f32_dpp v22, v22, v22 quad_perm:[2,3,0,1] row_mask:0xf bank_mask:0xf
  s_nop 1
  v_add_f32_dpp v22, v22, v22 row_half_mirror row_mask:0xf bank_mask:0xf
  s_nop 1
  v_add_f32_dpp v22, v22, v22 row_mirror row_mask:0xf bank_mask:0xf
  v_mov_b32 v21, v22
  s_nop 1
  v_permlane16_swap_b32 v22, v21
  v_add_f32 v22, v22, v21
  v_rcp_f32 v22, v22
  s_nop 0
  v_mul_f32 v20, v20, v22
  s_lshl_b32 s46, s27, 2
  v_readlane_b32 s4, v20, s46
  s_add_u32 s46, s46, 1
  v_readlane_b32 s5, v20, s46
  s_add_u32 s46, s46, 1
  v_readlane_b32 s6, v20, s46
  s_add_u32 s46, s46, 1
  v_readlane_b32 s7, v20, s46
  s_add_u32 s46, s46, 1
  s_mov_b64 exec, 15
  s_mov_b32 s47, 3200000
L_lw103:
  ds_read_b32 v8, v7 offset:80
  s_waitcnt lgkmcnt(0)
  v_cmp_gt_u32 vcc, 0x3b, v8
  s_cbranch_vccz L_lwd104
  s_sleep 2
  s_sub_u32 s47, s47, 1
  s_cbranch_scc0 L_lw103
L_lwd104:
  s_mov_b64 exec, -1
  s_add_u32 s46, s23, 56
  s_lshr_b32 s47, s2, 3
  s_lshl_b64 exec, 1, s47
  buffer_store_dwordx2 v[70:71], v108, s[40:43], s46 offen
  s_not_b32 exec_lo, exec_lo
  s_mov_b32 exec_hi, 1
  buffer_load_dwordx2 v[20:21], v108, s[40:43], s46 offen sc1
  s_waitcnt vmcnt(0)
  v_cmp_eq_u64 vcc, s[30:31], v[20:21]
  s_mov_b64 exec, 1
  s_bcnt1_i32_b32 s47, vcc_lo
  v_readlane_b32 s48, v20, 32
  v_readlane_b32 s49, v21, 32
  s_cmp_eq_u32 s49, s30
  s_cselect_b32 s19, s48, s19
  s_mov_b32 s48, s19
  s_add_u32 s48, s48, s47
  s_cmp_ge_u32 s48, 32
  s_cselect_b32 s49, 1, 0
  s_cmp_ge_u32 s48, 39
  s_cselect_b32 s49, 2, s49
  s_cmp_lt_u32 s48, 20
  s_cselect_b32 s49, 3, s49
  v_mov_b32 v8, s49
  ds_write_b32 v7, v8 offset:4
  s_mov_b64 exec, -1
  v_add_u32 v24, 0, v110
  v_add_u32 v25, 27648, v110
  v_add_u32 v26, 55296, v110
  v_add_u32 v27, 82944, v110
  s_add_u32 s18, s31, 2
  v_mov_b32 v35, s18
  v_add_u32 v28, 384, v28
  s_mov_b32 s32, 1
  v_lshrrev_b32 v104, 2, v1
  v_mul_u32_u24 v104, 160, v104
  v_and_b32 v105, 3, v1
  v_lshl_add_u32 v104, v105, 3, v104
  s_lshl_b32 s46, s28, 5
  s_add_u32 s46, s46, 110592
  v_add_u32 v104, s46, v104
  v_and_b32 v105, 1, v1
  v_mul_u32_u24 v105, 384, v105
  v_lshrrev_b32 v106, 4, v1
  v_lshl_add_u32 v105, v106, 4, v105
  v_add_u32 v105, 161024, v105
  s_mul_i32 s60, s27, 5
  s_add_u32 s60, s60, s28
  s_lshl_b32 s60, s60, 5
  s_add_u32 s60, s60, s26
  s_lshl_b32 s60, s60, 8
  s_add_u32 s60, s60, 1101824
  s_cmp_lt_u32 s26, 5
  s_cselect_b32 s61, 1, 0
  s_lshl_b32 s62, s33, 13
  s_add_u32 s62, s62, 1101824
  s_add_u32 s63, s62, 4096
  s_mov_b32 s96, s20
  s_mov_b32 s97, s21
  v_lshrrev_b32 v20, 1, v1
  v_lshlrev_b32 v20, 13, v20
  v_and_b32 v21, 1, v1
  v_lshl_add_u32 v20, v21, 7, v20
  s_mov_b64 exec, 0x3ff
  buffer_load_dword v21, v20, s[40:43], s60 offen sc1
  s_mov_b64 exec, -1
  s_mov_b32 s14, 0xffff
  s_mov_b32 s15, 0xffff
  s_setprio 3
  s_branch L_h_bar
L_pb1:
  buffer_store_dwordx4 v[232:235], v66, s[40:43], s94 offen offset:0 sc1
  s_branch L_pbd2
L_pb41:
  buffer_store_dwordx4 v[236:239], v66, s[40:43], s92 offen offset:0 sc1
  s_branch L_pbd42
L_pb59:
  buffer_store_dwordx4 v[32:35], v66, s[40:43], s35 offen offset:0 sc1
  s_branch L_pbd60
L_pb93:
  buffer_store_dwordx4 v[236:239], v66, s[40:43], s92 offen offset:0 sc1
  s_branch L_pbd94
L_stream:
  s_setprio 2
  s_sub_u32 s52, s28, 1
  s_lshl_b32 s22, s27, 2
  s_add_u32 s22, s22, s52
  s_mul_i32 s46, s26, 112
  s_add_u32 s22, s22, s46
  s_and_b32 s22, s22, 511
  s_mul_i32 s22, s22, 3072
  s_mul_i32 s46, s26, 1572864
  s_mul_i32 s44, s52, 27648
  s_add_u32 s45, s44, 27648
  s_mov_b32 m0, s44
  s_mov_b32 s58, s44
  v_lshlrev_b32 v66, 4, v1
  s_mov_b32 s34, 1572864
  s_mov_b32 s35, 0x00020000
  s_waitcnt lgkmcnt(0)
  s_add_u32 s32, s6, s46
  s_addc_u32 s33, s7, 0
  buffer_load_dwordx4 v66, s[32:35], s22 offen offset:0 nt lds
  buffer_load_dwordx4 v66, s[32:35], s22 offen offset:1024 nt lds
  buffer_load_dwordx4 v66, s[32:35], s22 offen offset:2048 nt lds
  s_add_u32 s22, s22, 98304
  s_sub_u32 s47, s22, 1572864
  s_cselect_b32 s22, s22, s47
  s_add_u32 m0, m0, 3072
  s_cmp_eq_u32 m0, s45
  s_cselect_b32 m0, s44, m0
  s_barrier
  buffer_load_dwordx4 v66, s[32:35], s22 offen offset:0 nt lds
  buffer_load_dwordx4 v66, s[32:35], s22 offen offset:1024 nt lds
  buffer_load_dwordx4 v66, s[32:35], s22 offen offset:2048 nt lds
  s_add_u32 s22, s22, 98304
  s_sub_u32 s47, s22, 1572864
  s_cselect_b32 s22, s22, s47
  s_add_u32 m0, m0, 3072
  s_cmp_eq_u32 m0, s45
  s_cselect_b32 m0, s44, m0
  s_load_dwordx2 s[30:31], s[24:25], 0
  s_mov_b32 s47, 1527808
  s_load_dwordx2 s[4:5], s[24:25], s47
  s_mov_b32 s40, s24
  s_mov_b32 s41, s25
  s_add_u32 s36, s8, s46
  s_addc_u32 s37, s9, 0
  s_add_u32 s38, s32, 50331648
  s_addc_u32 s39, s33, 0
  s_add_u32 s56, s36, 50331648
  s_addc_u32 s57, s37, 0
  v_lshrrev_b32 v3, 3, v1
  v_mul_u32_u24 v3, 384, v3
  v_and_b32 v7, 7, v1
  v_lshl_add_u32 v3, v7, 4, v3
  v_add_u32 v4, s58, v3
  v_and_b32 v5, 56, v1
  v_lshlrev_b32 v5, 2, v5
  v_lshlrev_b32 v60, 4, v7
  v_add_u32 v60, 160256, v60
  v_and_b32 v6, 1, v7
  v_lshlrev_b32 v6, 4, v6
  v_mov_b32 v8, 0xffff
  v_lshlrev_b32 v6, v6, v8
  v_lshrrev_b32 v7, 1, v7
  v_cmp_eq_u32 vcc, 0, v7
  s_nop 1
  v_cndmask_b32 v44, 0, v6, vcc
  v_cmp_eq_u32 vcc, 1, v7
  s_nop 1
  v_cndmask_b32 v45, 0, v6, vcc
  v_cmp_eq_u32 vcc, 2, v7
  s_nop 1
  v_cndmask_b32 v46, 0, v6, vcc
  v_cmp_eq_u32 vcc, 3, v7
  s_nop 1
  v_cndmask_b32 v47, 0, v6, vcc
  v_lshrrev_b32 v61, 5, v1
  v_mul_u32_u24 v61, 768, v61
  v_and_b32 v7, 7, v1
  v_lshl_add_u32 v61, v7, 5, v61
  v_and_b32 v7, 16, v1
  v_add_u32 v61, v61, v7
  v_mov_b32 v63, 1
  s_lshl_b32 s46, s52, 2
  s_add_u32 s46, s46, 162192
  v_mov_b32 v64, s46
  v_mov_b32 v65, 162112
  v_mov_b32 v67, 2
  v_lshlrev_b32 v77, 2, v1
  v_add_u32 v77, 162192, v77
  v_cmp_gt_u32 vcc, 4, v1
  v_mov_b32 v78, 162116
  s_nop 0
  v_cndmask_b32 v77, v78, v77, vcc
  v_add_u32 v20, 0, v1
  v_mul_u32_u24 v21, 6554, v20
  v_lshrrev_b32 v21, 16, v21
  v_mul_u32_u24 v22, 10, v21
  v_sub_u32 v22, v20, v22
  v_mul_u32_u24 v21, 1280, v21
  v_lshl_add_u32 v72, v22, 4, v21
  v_add_u32 v20, 64, v1
  v_mul_u32_u24 v21, 6554, v20
  v_lshrrev_b32 v21, 16, v21
  v_mul_u32_u24 v22, 10, v21
  v_sub_u32 v22, v20, v22
  v_mul_u32_u24 v21, 1280, v21
  v_lshl_add_u32 v73, v22, 4, v21
  v_add_u32 v20, 128, v1
  v_mul_u32_u24 v21, 6554, v20
  v_lshrrev_b32 v21, 16, v21
  v_mul_u32_u24 v22, 10, v21
  v_sub_u32 v22, v20, v22
  v_mul_u32_u24 v21, 1280, v21
  v_lshl_add_u32 v74, v22, 4, v21
  v_add_u32 v20, 192, v1
  v_mul_u32_u24 v21, 6554, v20
  v_lshrrev_b32 v21, 16, v21
  v_mul_u32_u24 v22, 10, v21
  v_sub_u32 v22, v20, v22
  v_mul_u32_u24 v21, 1280, v21
  v_lshl_add_u32 v75, v22, 4, v21
  v_add_u32 v20, 256, v1
  v_mul_u32_u24 v21, 6554, v20
  v_lshrrev_b32 v21, 16, v21
  v_mul_u32_u24 v22, 10, v21
  v_sub_u32 v22, v20, v22
  v_mul_u32_u24 v21, 1280, v21
  v_lshl_add_u32 v76, v22, 4, v21
  s_lshl_b32 s46, s26, 2
  s_add_u32 s46, s46, s52
  s_mul_i32 s46, s46, 61440
  s_mul_i32 s47, s27, 160
  s_add_u32 s46, s46, s47
  s_add_u32 s96, s12, s46
  s_addc_u32 s97, s13, 0
  s_sub_u32 s98, 7864320, s46
  s_mov_b32 s99, 0x00020000
  v_lshrrev_b32 v104, 2, v1
  v_mul_u32_u24 v104, 160, v104
  v_and_b32 v105, 3, v1
  v_lshl_add_u32 v104, v105, 3, v104
  s_lshl_b32 s46, s28, 5
  s_add_u32 s46, s46, 110592
  v_add_u32 v104, s46, v104
  v_and_b32 v105, 1, v1
  v_mul_u32_u24 v105, 384, v105
  v_lshrrev_b32 v106, 4, v1
  v_lshl_add_u32 v105, v106, 4, v105
  v_add_u32 v105, 161024, v105
  s_mul_i32 s60, s27, 5
  s_add_u32 s60, s60, s28
  s_lshl_b32 s60, s60, 5
  s_add_u32 s60, s60, s26
  s_lshl_b32 s60, s60, 8
  s_add_u32 s60, s60, 1101824
  s_mov_b32 s61, 0
  s_mov_b32 s55, 0x20000000
  s_mov_b32 s54, 0
  s_mov_b32 s53, 0
  s_mov_b32 s62, 0
  s_mov_b32 s63, 0
  s_mov_b32 s29, 0
  s_waitcnt lgkmcnt(0)
  s_add_u32 s30, s30, 0x7f4a7c15
  s_addc_u32 s31, s31, 0x9e3779b9
  s_add_u32 s30, s30, s4
  s_addc_u32 s31, s31, s5
  v_mov_b32 v70, s30
  v_mov_b32 v71, s31
  s_mov_b32 s53, -1
L_s_fill:
  ds_read_b32 v68, v65
  v_add_u32 v67, 1, v67
  ds_write_b32 v64, v67
  s_waitcnt vmcnt(5)
  buffer_load_dwordx4 v66, s[32:35], s22 offen offset:0 nt lds
  s_waitcnt vmcnt(5)
  buffer_load_dwordx4 v66, s[32:35], s22 offen offset:1024 nt lds
  s_waitcnt vmcnt(5)
  buffer_load_dwordx4 v66, s[32:35], s22 offen offset:2048 nt lds
  s_add_u32 s22, s22, 98304
  s_sub_u32 s47, s22, 1572864
  s_cselect_b32 s22, s22, s47
  s_add_u32 m0, m0, 3072
  s_cmp_eq_u32 m0, s45
  s_cselect_b32 m0, s44, m0
  s_add_u32 s55, s55, 0x10000000
  s_add_u32 s53, s53, 1
  s_waitcnt lgkmcnt(0)
  v_readfirstlane_b32 s46, v68
  s_cmp_eq_u32 s46, 0
  s_cbranch_scc0 L_s_q
  s_cmp_lt_u32 s53, 6
  s_cbranch_scc1 L_s_fill
  s_mov_b64 exec, 1
  s_mov_b32 s47, 3200000
L_lw105:
  ds_read_b32 v7, v65 offset:0
  s_waitcnt lgkmcnt(0)
  v_cmp_gt_u32 vcc, 0x1, v7
  s_cbranch_vccz L_lwd106
  s_sleep 1
  s_sub_u32 s47, s47, 1
  s_cbranch_scc0 L_lw105
L_lwd106:
  s_mov_b64 exec, -1
L_s_q:
  s_mov_b32 s59, 1
L_s_kseg:
  ds_read_b128 v[20:23], v60
  ds_read_b128 v[24:27], v60 offset:128
  ds_read_b128 v[28:31], v60 offset:256
  v_add_u32 v60, 384, v60
  s_mov_b32 s23, 0
L_k_half:
  s_mov_b32 s50, 0x01010101
  s_mov_b32 s51, 0x01010101
L_k:
  s_cmp_eq_u32 s53, 0
  s_cbranch_scc0 L_k_back
L_k_n:
  s_cmp_eq_u32 s63, 1
  s_cbranch_scc1 L_k_b1
  s_cmp_eq_u32 s63, 2
  s_cbranch_scc1 L_k_b2
  s_cmp_eq_u32 s63, 3
  s_cbranch_scc1 L_k_b3
  s_waitcnt vmcnt(4)
  buffer_load_dwordx4 v66, s[32:35], s22 offen offset:0 nt lds
  ds_read_b128 v[8:11], v4
  ds_read_b128 v[12:15], v4 offset:128
  ds_read_b128 v[16:19], v4 offset:256
  ds_read_b32 v69, v77
  v_add_u32 v67, 1, v67
  ds_write_b32 v64, v67
  s_add_u32 s58, s58, 3072
  s_cmp_eq_u32 s58, s45
  s_cselect_b32 s58, s44, s58
  s_waitcnt vmcnt(4)
  buffer_load_dwordx4 v66, s[32:35], s22 offen offset:1024 nt lds
  s_waitcnt lgkmcnt(0)
  v_dot2_f32_bf16 v32, v8, v20, 0
  v_dot2_f32_bf16 v33, v12, v24, 0
  v_dot2_f32_bf16 v34, v16, v28, 0
  v_dot2_f32_bf16 v32, v9, v21, v32
  v_dot2_f32_bf16 v33, v13, v25, v33
  v_dot2_f32_bf16 v34, v17, v29, v34
  v_dot2_f32_bf16 v32, v10, v22, v32
  v_dot2_f32_bf16 v33, v14, v26, v33
  v_dot2_f32_bf16 v34, v18, v30, v34
  v_dot2_f32_bf16 v32, v11, v23, v32
  v_dot2_f32_bf16 v33, v15, v27, v33
  v_dot2_f32_bf16 v34, v19, v31, v34
  v_add_u32 v4, s58, v3
  v_readlane_b32 s63, v69, 4
  v_cmp_ge_u32 vcc, v69, v67
  s_and_b32 s46, vcc_lo, 15
  s_bcnt1_i32_b32 s46, s46
  s_cmp_eq_u32 s46, 3
  s_waitcnt vmcnt(5)
  s_cbranch_scc1 L_eq107
  s_waitcnt vmcnt(4)
  s_cmp_eq_u32 s46, 0
  s_cbranch_scc0 L_eq107
  s_waitcnt vmcnt(3)
L_eq107:
  buffer_load_dwordx4 v66, s[32:35], s22 offen offset:2048 nt lds
L_k_a:
  s_add_u32 s22, s22, 98304
  s_sub_u32 s47, s22, 1572864
  s_cselect_b32 s22, s22, s47
  s_add_u32 m0, m0, 3072
  s_cmp_eq_u32 m0, s45
  s_cselect_b32 m0, s44, m0
  s_add_u32 s55, s55, 0x10000000
  s_cbranch_scc1 L_k_seg
L_k_c:
  v_add_f32 v32, v32, v33
  v_add_f32 v32, v32, v34
  s_nop 1
  v_add_f32_dpp v32, v32, v32 quad_perm:[1,0,3,2] row_mask:0xf bank_mask:0xf
  s_nop 1
  v_add_f32_dpp v32, v32, v32 quad_perm:[2,3,0,1] row_mask:0xf bank_mask:0xf
  s_nop 1
  v_add_f32_dpp v32, v32, v32 row_half_mirror row_mask:0xf bank_mask:0xf
  v_cndmask_b32 v35, v35, v32, s[50:51]
  s_lshl_b64 s[50:51], s[50:51], 1
  s_bitcmp1_b32 s50, 8
  s_cbranch_scc0 L_k
  s_cmp_eq_u32 s23, 0
  s_cbranch_scc0 L_k_end
  v_mov_b32 v36, v35
  s_mov_b32 s23, 1
  s_branch L_k_half
L_k_back:
  s_xor_b32 s59, s59, 1
  s_cbranch_scc1 L_k_n
  s_sub_u32 s53, s53, 1
  ds_read_b128 v[8:11], v4
  ds_read_b128 v[12:15], v4 offset:128
  ds_read_b128 v[16:19], v4 offset:256
  ds_read_b32 v69, v77
  s_add_u32 s58, s58, 3072
  s_cmp_eq_u32 s58, s45
  s_cselect_b32 s58, s44, s58
  s_waitcnt lgkmcnt(0)
  v_dot2_f32_bf16 v32, v8, v20, 0
  v_dot2_f32_bf16 v33, v12, v24, 0
  v_dot2_f32_bf16 v34, v16, v28, 0
  v_dot2_f32_bf16 v32, v9, v21, v32
  v_dot2_f32_bf16 v33, v13, v25, v33
  v_dot2_f32_bf16 v34, v17, v29, v34
  v_dot2_f32_bf16 v32, v10, v22, v32
  v_dot2_f32_bf16 v33, v14, v26, v33
  v_dot2_f32_bf16 v34, v18, v30, v34
  v_dot2_f32_bf16 v32, v11, v23, v32
  v_dot2_f32_bf16 v33, v15, v27, v33
  v_dot2_f32_bf16 v34, v19, v31, v34
  v_add_u32 v4, s58, v3
  v_readlane_b32 s63, v69, 4
  s_branch L_k_c
L_k_b1:
  s_waitcnt vmcnt(5)
  buffer_load_dwordx4 v66, s[32:35], s22 offen offset:0 nt lds
  ds_read_b128 v[8:11], v4
  ds_read_b128 v[12:15], v4 offset:128
  ds_read_b128 v[16:19], v4 offset:256
  ds_read_b32 v69, v77
  v_add_u32 v67, 1, v67
  ds_write_b32 v64, v67
  s_add_u32 s58, s58, 3072
  s_cmp_eq_u32 s58, s45
  s_cselect_b32 s58, s44, s58
  s_waitcnt vmcnt(5)
  buffer_load_dwordx4 v66, s[32:35], s22 offen offset:1024 nt lds
  s_waitcnt lgkmcnt(0)
  v_dot2_f32_bf16 v32, v8, v20, 0
  v_dot2_f32_bf16 v33, v12, v24, 0
  v_dot2_f32_bf16 v34, v16, v28, 0
  v_dot2_f32_bf16 v32, v9, v21, v32
  v_dot2_f32_bf16 v33, v13, v25, v33
  v_dot2_f32_bf16 v34, v17, v29, v34
  v_dot2_f32_bf16 v32, v10, v22, v32
  v_dot2_f32_bf16 v33, v14, v26, v33
  v_dot2_f32_bf16 v34, v18, v30, v34
  v_dot2_f32_bf16 v32, v11, v23, v32
  v_dot2_f32_bf16 v33, v15, v27, v33
  v_dot2_f32_bf16 v34, v19, v31, v34
  v_add_u32 v4, s58, v3
  v_readlane_b32 s63, v69, 4
  v_cmp_ge_u32 vcc, v69, v67
  s_and_b32 s46, vcc_lo, 15
  s_bcnt1_i32_b32 s46, s46
  s_cmp_eq_u32 s46, 3
  s_waitcnt vmcnt(6)
  s_cbranch_scc1 L_eq108
  s_waitcnt vmcnt(5)
  s_cmp_eq_u32 s46, 0
  s_cbranch_scc0 L_eq108
  s_waitcnt vmcnt(4)
L_eq108:
  buffer_load_dwordx4 v66, s[32:35], s22 offen offset:2048 nt lds
  s_branch L_k_a
L_k_b2:
  s_waitcnt vmcnt(6)
  buffer_load_dwordx4 v66, s[32:35], s22 offen offset:0 nt lds
  ds_read_b128 v[8:11], v4
  ds_read_b128 v[12:15], v4 offset:128
  ds_read_b128 v[16:19], v4 offset:256
  ds_read_b32 v69, v77
  v_add_u32 v67, 1, v67
  ds_write_b32 v64, v67
  s_add_u32 s58, s58, 3072
  s_cmp_eq_u32 s58, s45
  s_cselect_b32 s58, s44, s58
  s_waitcnt vmcnt(6)
  buffer_load_dwordx4 v66, s[32:35], s22 offen offset:1024 nt lds
  s_waitcnt lgkmcnt(0)
  v_dot2_f32_bf16 v32, v8, v20, 0
  v_dot2_f32_bf16 v33, v12, v24, 0
  v_dot2_f32_bf16 v34, v16, v28, 0
  v_dot2_f32_bf16 v32, v9, v21, v32
  v_dot2_f32_bf16 v33, v13, v25, v33
  v_dot2_f32_bf16 v34, v17, v29, v34
  v_dot2_f32_bf16 v32, v10, v22, v32
  v_dot2_f32_bf16 v33, v14, v26, v33
  v_dot2_f32_bf16 v34, v18, v30, v34
  v_dot2_f32_bf16 v32, v11, v23, v32
  v_dot2_f32_bf16 v33, v15, v27, v33
  v_dot2_f32_bf16 v34, v19, v31, v34
  v_add_u32 v4, s58, v3
  v_readlane_b32 s63, v69, 4
  v_cmp_ge_u32 vcc, v69, v67
  s_and_b32 s46, vcc_lo, 15
  s_bcnt1_i32_b32 s46, s46
  s_cmp_eq_u32 s46, 3
  s_waitcnt vmcnt(7)
  s_cbranch_scc1 L_eq109
  s_waitcnt vmcnt(6)
  s_cmp_eq_u32 s46, 0
  s_cbranch_scc0 L_eq109
  s_waitcnt vmcnt(5)
L_eq109:
  buffer_load_dwordx4 v66, s[32:35], s22 offen offset:2048 nt lds
  s_branch L_k_a
L_k_b3:
  s_waitcnt vmcnt(3)
  buffer_load_dwordx4 v66, s[32:35], s22 offen offset:0 nt lds
  ds_read_b128 v[8:11], v4
  ds_read_b128 v[12:15], v4 offset:128
  ds_read_b128 v[16:19], v4 offset:256
  ds_read_b32 v69, v77
  v_add_u32 v67, 1, v67
  ds_write_b32 v64, v67
  s_add_u32 s58, s58, 3072
  s_cmp_eq_u32 s58, s45
  s_cselect_b32 s58, s44, s58
  s_waitcnt vmcnt(4)
  buffer_load_dwordx4 v66, s[32:35], s22 offen offset:1024 nt lds
  s_waitcnt lgkmcnt(0)
  v_dot2_f32_bf16 v32, v8, v20, 0
  v_dot2_f32_bf16 v33, v12, v24, 0
  v_dot2_f32_bf16 v34, v16, v28, 0
  v_dot2_f32_bf16 v32, v9, v21, v32
  v_dot2_f32_bf16 v33, v13, v25, v33
  v_dot2_f32_bf16 v34, v17, v29, v34
  v_dot2_f32_bf16 v32, v10, v22, v32
  v_dot2_f32_bf16 v33, v14, v26, v33
  v_dot2_f32_bf16 v34, v18, v30, v34
  v_dot2_f32_bf16 v32, v11, v23, v32
  v_dot2_f32_bf16 v33, v15, v27, v33
  v_dot2_f32_bf16 v34, v19, v31, v34
  v_add_u32 v4, s58, v3
  v_readlane_b32 s63, v69, 4
  v_cmp_ge_u32 vcc, v69, v67
  s_and_b32 s46, vcc_lo, 15
  s_bcnt1_i32_b32 s46, s46
  s_cmp_eq_u32 s46, 3
  s_waitcnt vmcnt(4)
  s_cbranch_scc1 L_eq110
  s_waitcnt vmcnt(3)
  s_cmp_eq_u32 s46, 0
  s_cbranch_scc0 L_eq110
  s_waitcnt vmcnt(2)
L_eq110:
  buffer_load_dwordx4 v66, s[32:35], s22 offen offset:2048 nt lds
  s_branch L_k_a
L_k_seg:
  s_mov_b64 s[32:33], s[36:37]
  s_mov_b64 s[36:37], s[38:39]
  s_mov_b64 s[38:39], s[56:57]
  s_add_u32 s54, s54, 1
  s_branch L_k_c
L_k_end:
  s_waitcnt vmcnt(5)
  buffer_load_dwordx4 v66, s[32:35], s22 offen offset:0 nt lds
  v_add_u32 v67, 1, v67
  ds_write_b32 v64, v67
  s_mov_b32 s46, 0xffff0000
  v_cvt_pk_bf16_f32 v32, v36, v35
  v_lshlrev_b32 v33, 16, v32
  v_and_b32 v34, s46, v32
  v_mul_f32 v33, 0x3d93cd3a, v33
  v_mul_f32 v34, 0x3d93cd3a, v34
  v_cvt_pk_bf16_f32 v32, v33, v34
  v_lshlrev_b32 v33, 16, v32
  v_and_b32 v34, s46, v32
  v_max_f32 v40, v33, v34
  s_nop 1
  v_max_f32_dpp v40, v40, v40 quad_perm:[1,0,3,2] row_mask:0xf bank_mask:0xf
  s_nop 1
  v_max_f32_dpp v40, v40, v40 quad_perm:[2,3,0,1] row_mask:0xf bank_mask:0xf
  s_nop 1
  v_max_f32_dpp v40, v40, v40 row_half_mirror row_mask:0xf bank_mask:0xf
  s_nop 1
  v_max_f32_dpp v40, v40, v40 row_mirror row_mask:0xf bank_mask:0xf
  v_mov_b32 v42, v40
  s_nop 1
  v_permlane16_swap_b32 v40, v42
  v_max_f32 v40, v40, v42
  v_mov_b32 v42, v40
  s_nop 1
  v_permlane32_swap_b32 v40, v42
  v_max_f32 v40, v40, v42
  s_waitcnt vmcnt(5)
  buffer_load_dwordx4 v66, s[32:35], s22 offen offset:1024 nt lds
  v_sub_f32 v33, v33, v40
  v_sub_f32 v34, v34, v40
  v_mul_f32 v33, 0x3fb8aa3b, v33
  v_mul_f32 v34, 0x3fb8aa3b, v34
  v_exp_f32 v33, v33
  v_exp_f32 v34, v34
  s_mul_i32 s46, s52, 1536
  v_cvt_pk_bf16_f32 v37, v33, v33
  v_cvt_pk_bf16_f32 v38, v34, v34
  v_add_f32 v41, v33, v34
  s_nop 1
  v_add_f32_dpp v41, v41, v41 quad_perm:[1,0,3,2] row_mask:0xf bank_mask:0xf
  s_nop 1
  v_add_f32_dpp v41, v41, v41 quad_perm:[2,3,0,1] row_mask:0xf bank_mask:0xf
  s_nop 1
  v_add_f32_dpp v41, v41, v41 row_half_mirror row_mask:0xf bank_mask:0xf
  s_nop 1
  v_add_f32_dpp v41, v41, v41 row_mirror row_mask:0xf bank_mask:0xf
  v_mov_b32 v42, v41
  s_nop 1
  v_permlane16_swap_b32 v41, v42
  v_add_f32 v41, v41, v42
  v_mov_b32 v42, v41
  s_nop 1
  v_permlane32_swap_b32 v41, v42
  v_add_f32 v41, v41, v42
  s_waitcnt vmcnt(5)
  buffer_load_dwordx4 v66, s[32:35], s22 offen offset:2048 nt lds
  s_add_u32 s22, s22, 98304
  s_sub_u32 s47, s22, 1572864
  s_cselect_b32 s22, s22, s47
  s_add_u32 m0, m0, 3072
  s_cmp_eq_u32 m0, s45
  s_cselect_b32 m0, s44, m0
  s_add_u32 s55, s55, 0x10000000
  v_mov_b32 v6, v5
  ds_read_b128 v[8:11], v4
  ds_read_b128 v[12:15], v4 offset:128
  ds_read_b128 v[16:19], v4 offset:256
  ds_bpermute_b32 v39, v6, v37
  s_add_u32 s58, s58, 3072
  s_cmp_eq_u32 s58, s45
  s_cselect_b32 s58, s44, s58
  v_mov_b32 v48, 0
  v_mov_b32 v49, 0
  v_mov_b32 v50, 0
  v_mov_b32 v51, 0
  v_mov_b32 v52, 0
  v_mov_b32 v53, 0
  v_mov_b32 v54, 0
  v_mov_b32 v55, 0
  v_mov_b32 v56, 0
  v_mov_b32 v57, 0
  v_mov_b32 v58, 0
  v_mov_b32 v59, 0
  s_add_u32 s46, s46, 151552
  s_cmp_eq_u32 s29, 0
  s_cselect_b32 s46, s46, s44
  v_add_u32 v62, s46, v61
  s_lshl_b32 s46, s29, 2
  s_add_u32 s46, s46, s52
  s_lshl_b32 s47, s46, 3
  s_add_u32 s47, s47, 162048
  s_lshl_b32 s46, s46, 2
  s_add_u32 s46, s46, 162128
  v_mov_b32 v42, s47
  v_mov_b32 v43, s46
  s_mov_b64 exec, 1
  ds_write_b64 v42, v[40:41]
  ds_write_b32 v43, v63
  s_mov_b64 exec, -1
  s_mov_b32 s23, 0
  s_mov_b32 s50, 0x20000000
  s_waitcnt lgkmcnt(0)
  v_and_b32 v40, v39, v44
  v_and_b32 v41, v39, v45
  v_and_b32 v42, v39, v46
  v_and_b32 v43, v39, v47
  v_add_u32 v4, s58, v3
  v_add_u32 v6, 4, v6
  v_mfma_f32_16x16x32_bf16 v[48:51], v[40:43], v[8:11], v[48:51]
  v_mfma_f32_16x16x32_bf16 v[52:55], v[40:43], v[12:15], v[52:55]
  v_mfma_f32_16x16x32_bf16 v[56:59], v[40:43], v[16:19], v[56:59]
  s_branch L_v
L_v_half:
  v_mov_b32 v6, v5
  s_mov_b32 s50, 0
L_v:
  s_cmp_eq_u32 s63, 1
  s_cbranch_scc1 L_v_b1
  s_cmp_eq_u32 s63, 2
  s_cbranch_scc1 L_v_b2
  s_cmp_eq_u32 s63, 3
  s_cbranch_scc1 L_v_b3
  s_waitcnt vmcnt(4)
  buffer_load_dwordx4 v66, s[32:35], s22 offen offset:0 nt lds
  ds_read_b128 v[8:11], v4
  ds_read_b128 v[12:15], v4 offset:128
  ds_read_b128 v[16:19], v4 offset:256
  ds_bpermute_b32 v39, v6, v37
  ds_read_b32 v69, v77
  v_add_u32 v67, 1, v67
  ds_write_b32 v64, v67
  s_add_u32 s58, s58, 3072
  s_cmp_eq_u32 s58, s45
  s_cselect_b32 s58, s44, s58
  s_waitcnt vmcnt(4)
  buffer_load_dwordx4 v66, s[32:35], s22 offen offset:1024 nt lds
  s_waitcnt lgkmcnt(0)
  v_and_b32 v40, v39, v44
  v_and_b32 v41, v39, v45
  v_and_b32 v42, v39, v46
  v_and_b32 v43, v39, v47
  v_add_u32 v4, s58, v3
  v_add_u32 v6, 4, v6
  v_mfma_f32_16x16x32_bf16 v[48:51], v[40:43], v[8:11], v[48:51]
  v_mfma_f32_16x16x32_bf16 v[52:55], v[40:43], v[12:15], v[52:55]
  v_mfma_f32_16x16x32_bf16 v[56:59], v[40:43], v[16:19], v[56:59]
  v_readlane_b32 s63, v69, 4
  v_cmp_ge_u32 vcc, v69, v67
  s_and_b32 s46, vcc_lo, 15
  s_bcnt1_i32_b32 s46, s46
  s_cmp_eq_u32 s46, 3
  s_waitcnt vmcnt(5)
  s_cbranch_scc1 L_eq111
  s_waitcnt vmcnt(4)
  s_cmp_eq_u32 s46, 0
  s_cbranch_scc0 L_eq111
  s_waitcnt vmcnt(3)
L_eq111:
  buffer_load_dwordx4 v66, s[32:35], s22 offen offset:2048 nt lds
L_v_a:
  s_add_u32 s22, s22, 98304
  s_sub_u32 s47, s22, 1572864
  s_cselect_b32 s22, s22, s47
  s_add_u32 m0, m0, 3072
  s_cmp_eq_u32 m0, s45
  s_cselect_b32 m0, s44, m0
  s_add_u32 s55, s55, 0x10000000
  s_cbranch_scc1 L_v_seg
L_v_c:
  s_add_u32 s50, s50, 0x20000000
  s_cbranch_scc0 L_v
  s_cmp_eq_u32 s23, 0
  s_cbranch_scc0 L_v_end
  v_mov_b32 v37, v38
  s_mov_b32 s23, 1
  s_branch L_v_half
L_v_b1:
  s_waitcnt vmcnt(5)
  buffer_load_dwordx4 v66, s[32:35], s22 offen offset:0 nt lds
  ds_read_b128 v[8:11], v4
  ds_read_b128 v[12:15], v4 offset:128
  ds_read_b128 v[16:19], v4 offset:256
  ds_bpermute_b32 v39, v6, v37
  ds_read_b32 v69, v77
  v_add_u32 v67, 1, v67
  ds_write_b32 v64, v67
  s_add_u32 s58, s58, 3072
  s_cmp_eq_u32 s58, s45
  s_cselect_b32 s58, s44, s58
  s_waitcnt vmcnt(5)
  buffer_load_dwordx4 v66, s[32:35], s22 offen offset:1024 nt lds
  s_waitcnt lgkmcnt(0)
  v_and_b32 v40, v39, v44
  v_and_b32 v41, v39, v45
  v_and_b32 v42, v39, v46
  v_and_b32 v43, v39, v47
  v_add_u32 v4, s58, v3
  v_add_u32 v6, 4, v6
  v_mfma_f32_16x16x32_bf16 v[48:51], v[40:43], v[8:11], v[48:51]
  v_mfma_f32_16x16x32_bf16 v[52:55], v[40:43], v[12:15], v[52:55]
  v_mfma_f32_16x16x32_bf16 v[56:59], v[40:43], v[16:19], v[56:59]
  v_readlane_b32 s63, v69, 4
  v_cmp_ge_u32 vcc, v69, v67
  s_and_b32 s46, vcc_lo, 15
  s_bcnt1_i32_b32 s46, s46
  s_cmp_eq_u32 s46, 3
  s_waitcnt vmcnt(6)
  s_cbranch_scc1 L_eq112
  s_waitcnt vmcnt(5)
  s_cmp_eq_u32 s46, 0
  s_cbranch_scc0 L_eq112
  s_waitcnt vmcnt(4)
L_eq112:
  buffer_load_dwordx4 v66, s[32:35], s22 offen offset:2048 nt lds
  s_branch L_v_a
L_v_b2:
  s_waitcnt vmcnt(6)
  buffer_load_dwordx4 v66, s[32:35], s22 offen offset:0 nt lds
  ds_read_b128 v[8:11], v4
  ds_read_b128 v[12:15], v4 offset:128
  ds_read_b128 v[16:19], v4 offset:256
  ds_bpermute_b32 v39, v6, v37
  ds_read_b32 v69, v77
  v_add_u32 v67, 1, v67
  ds_write_b32 v64, v67
  s_add_u32 s58, s58, 3072
  s_cmp_eq_u32 s58, s45
  s_cselect_b32 s58, s44, s58
  s_waitcnt vmcnt(6)
  buffer_load_dwordx4 v66, s[32:35], s22 offen offset:1024 nt lds
  s_waitcnt lgkmcnt(0)
  v_and_b32 v40, v39, v44
  v_and_b32 v41, v39, v45
  v_and_b32 v42, v39, v46
  v_and_b32 v43, v39, v47
  v_add_u32 v4, s58, v3
  v_add_u32 v6, 4, v6
  v_mfma_f32_16x16x32_bf16 v[48:51], v[40:43], v[8:11], v[48:51]
  v_mfma_f32_16x16x32_bf16 v[52:55], v[40:43], v[12:15], v[52:55]
  v_mfma_f32_16x16x32_bf16 v[56:59], v[40:43], v[16:19], v[56:59]
  v_readlane_b32 s63, v69, 4
  v_cmp_ge_u32 vcc, v69, v67
  s_and_b32 s46, vcc_lo, 15
  s_bcnt1_i32_b32 s46, s46
  s_cmp_eq_u32 s46, 3
  s_waitcnt vmcnt(7)
  s_cbranch_scc1 L_eq113
  s_waitcnt vmcnt(6)
  s_cmp_eq_u32 s46, 0
  s_cbranch_scc0 L_eq113
  s_waitcnt vmcnt(5)
L_eq113:
  buffer_load_dwordx4 v66, s[32:35], s22 offen offset:2048 nt lds
  s_branch L_v_a
L_v_b3:
  s_waitcnt vmcnt(3)
  buffer_load_dwordx4 v66, s[32:35], s22 offen offset:0 nt lds
  ds_read_b128 v[8:11], v4
  ds_read_b128 v[12:15], v4 offset:128
  ds_read_b128 v[16:19], v4 offset:256
  ds_bpermute_b32 v39, v6, v37
  ds_read_b32 v69, v77
  v_add_u32 v67, 1, v67
  ds_write_b32 v64, v67
  s_add_u32 s58, s58, 3072
  s_cmp_eq_u32 s58, s45
  s_cselect_b32 s58, s44, s58
  s_waitcnt vmcnt(4)
  buffer_load_dwordx4 v66, s[32:35], s22 offen offset:1024 nt lds
  s_waitcnt lgkmcnt(0)
  v_and_b32 v40, v39, v44
  v_and_b32 v41, v39, v45
  v_and_b32 v42, v39, v46
  v_and_b32 v43, v39, v47
  v_add_u32 v4, s58, v3
  v_add_u32 v6, 4, v6
  v_mfma_f32_16x16x32_bf16 v[48:51], v[40:43], v[8:11], v[48:51]
  v_mfma_f32_16x16x32_bf16 v[52:55], v[40:43], v[12:15], v[52:55]
  v_mfma_f32_16x16x32_bf16 v[56:59], v[40:43], v[16:19], v[56:59]
  v_readlane_b32 s63, v69, 4
  v_cmp_ge_u32 vcc, v69, v67
  s_and_b32 s46, vcc_lo, 15
  s_bcnt1_i32_b32 s46, s46
  s_cmp_eq_u32 s46, 3
  s_waitcnt vmcnt(4)
  s_cbranch_scc1 L_eq114
  s_waitcnt vmcnt(3)
  s_cmp_eq_u32 s46, 0
  s_cbranch_scc0 L_eq114
  s_waitcnt vmcnt(2)
L_eq114:
  buffer_load_dwordx4 v66, s[32:35], s22 offen offset:2048 nt lds
  s_branch L_v_a
L_v_end:
  s_mov_b32 exec_lo, 0x00ff00ff
  s_mov_b32 exec_hi, 0xff00ff00
  ds_write_b128 v62, v[48:51]
  ds_write_b128 v62, v[52:55] offset:256
  ds_write_b128 v62, v[56:59] offset:512
  s_mov_b64 exec, -1
  s_mov_b64 exec, 1
  s_mov_b32 s47, 3200000
L_lw115:
  ds_read_b32 v7, v65 offset:0
  s_waitcnt lgkmcnt(0)
  v_cmp_gt_u32 vcc, 0x2, v7
  s_cbranch_vccz L_lwd116
  s_sleep 1
  s_sub_u32 s47, s47, 1
  s_cbranch_scc0 L_lw115
L_lwd116:
  s_mov_b64 exec, -1
  s_mov_b32 s29, 1
  s_branch L_s_kseg
L_v_seg:
  s_mov_b64 s[32:33], s[36:37]
  s_mov_b64 s[36:37], s[38:39]
  s_mov_b64 s[38:39], s[56:57]
  s_add_u32 s54, s54, 1
  s_cmp_eq_u32 s54, 4
  s_cbranch_scc0 L_v_c
  s_mul_i32 s46, s52, 7680
  s_add_u32 m0, s46, 110592
  s_mov_b32 s47, 40960
  s_sub_u32 s46, s63, 1
  s_cmp_lt_u32 s46, 2
  s_cbranch_scc0 L_s_p1
  s_waitcnt vmcnt(6)
  ds_read_b128 v[8:11], v4
  ds_read_b128 v[12:15], v4 offset:128
  ds_read_b128 v[16:19], v4 offset:256
  ds_bpermute_b32 v39, v6, v37
  s_add_u32 s58, s58, 3072
  s_cmp_eq_u32 s58, s45
  s_cselect_b32 s58, s44, s58
  s_waitcnt lgkmcnt(0)
  v_and_b32 v40, v39, v44
  v_and_b32 v41, v39, v45
  v_and_b32 v42, v39, v46
  v_and_b32 v43, v39, v47
  v_add_u32 v4, s58, v3
  v_add_u32 v6, 4, v6
  v_mfma_f32_16x16x32_bf16 v[48:51], v[40:43], v[8:11], v[48:51]
  v_mfma_f32_16x16x32_bf16 v[52:55], v[40:43], v[12:15], v[52:55]
  v_mfma_f32_16x16x32_bf16 v[56:59], v[40:43], v[16:19], v[56:59]
  s_waitcnt vmcnt(6)
  buffer_load_dwordx4 v72, s[96:99], 0 offen  lds
  s_add_u32 m0, m0, 1024
  s_nop 0
  s_waitcnt vmcnt(6)
  buffer_load_dwordx4 v73, s[96:99], 0 offen  lds
  s_add_u32 m0, m0, 1024
  s_nop 0
  s_waitcnt vmcnt(6)
  buffer_load_dwordx4 v74, s[96:99], 0 offen  lds
  s_add_u32 m0, m0, 1024
  s_nop 0
  s_waitcnt vmcnt(6)
  ds_read_b128 v[8:11], v4
  ds_read_b128 v[12:15], v4 offset:128
  ds_read_b128 v[16:19], v4 offset:256
  ds_bpermute_b32 v39, v6, v37
  buffer_load_dwordx4 v75, s[96:99], 0 offen  lds
  s_add_u32 m0, m0, 1024
  s_nop 0
  s_add_u32 s58, s58, 3072
  s_cmp_eq_u32 s58, s45
  s_cselect_b32 s58, s44, s58
  s_waitcnt lgkmcnt(0)
  v_and_b32 v40, v39, v44
  v_and_b32 v41, v39, v45
  v_and_b32 v42, v39, v46
  v_and_b32 v43, v39, v47
  v_add_u32 v4, s58, v3
  v_add_u32 v6, 4, v6
  v_mfma_f32_16x16x32_bf16 v[48:51], v[40:43], v[8:11], v[48:51]
  v_mfma_f32_16x16x32_bf16 v[52:55], v[40:43], v[12:15], v[52:55]
  v_mfma_f32_16x16x32_bf16 v[56:59], v[40:43], v[16:19], v[56:59]
  ds_bpermute_b32 v39, v6, v37
  s_waitcnt lgkmcnt(0)
  v_and_b32 v40, v39, v44
  v_and_b32 v41, v39, v45
  v_and_b32 v42, v39, v46
  v_and_b32 v43, v39, v47
  s_waitcnt vmcnt(6)
  buffer_load_dwordx4 v76, s[96:99], 0 offen  lds
  s_add_u32 m0, m0, 1024
  s_nop 0
  s_waitcnt vmcnt(6)
  buffer_load_dwordx4 v72, s[96:99], s47 offen  lds
  s_add_u32 m0, m0, 1024
  s_nop 0
  s_waitcnt vmcnt(6)
  ds_read_b128 v[8:11], v4
  ds_read_b128 v[12:15], v4 offset:128
  ds_read_b128 v[16:19], v4 offset:256
  buffer_load_dwordx4 v73, s[96:99], s47 offen  lds
  s_add_u32 m0, m0, 1024
  s_waitcnt lgkmcnt(2)
  v_mfma_f32_16x16x32_bf16 v[48:51], v[40:43], v[8:11], v[48:51]
  s_waitcnt lgkmcnt(1)
  v_mfma_f32_16x16x32_bf16 v[52:55], v[40:43], v[12:15], v[52:55]
  s_waitcnt lgkmcnt(0)
  v_mfma_f32_16x16x32_bf16 v[56:59], v[40:43], v[16:19], v[56:59]
  s_mov_b32 exec_lo, 0x00ff00ff
  s_mov_b32 exec_hi, 0xff00ff00
  s_nop 3
  ds_write_b128 v62, v[48:51]
  ds_write_b128 v62, v[52:55] offset:256
  ds_write_b128 v62, v[56:59] offset:512
  s_mov_b64 exec, -1
  s_mov_b32 exec_hi, 0
  buffer_load_dwordx4 v74, s[96:99], s47 offen  lds
  s_mov_b64 exec, -1
  s_branch L_s_p2
L_s_p1:
  s_waitcnt vmcnt(6)
  ds_read_b128 v[8:11], v4
  ds_read_b128 v[12:15], v4 offset:128
  ds_read_b128 v[16:19], v4 offset:256
  ds_bpermute_b32 v39, v6, v37
  s_add_u32 s58, s58, 3072
  s_cmp_eq_u32 s58, s45
  s_cselect_b32 s58, s44, s58
  s_waitcnt lgkmcnt(0)
  v_and_b32 v40, v39, v44
  v_and_b32 v41, v39, v45
  v_and_b32 v42, v39, v46
  v_and_b32 v43, v39, v47
  v_add_u32 v4, s58, v3
  v_add_u32 v6, 4, v6
  v_mfma_f32_16x16x32_bf16 v[48:51], v[40:43], v[8:11], v[48:51]
  v_mfma_f32_16x16x32_bf16 v[52:55], v[40:43], v[12:15], v[52:55]
  v_mfma_f32_16x16x32_bf16 v[56:59], v[40:43], v[16:19], v[56:59]
  s_waitcnt vmcnt(4)
  buffer_load_dwordx4 v72, s[96:99], 0 offen  lds
  s_add_u32 m0, m0, 1024
  s_nop 0
  s_waitcnt vmcnt(4)
  ds_read_b128 v[8:11], v4
  ds_read_b128 v[12:15], v4 offset:128
  ds_read_b128 v[16:19], v4 offset:256
  ds_bpermute_b32 v39, v6, v37
  buffer_load_dwordx4 v73, s[96:99], 0 offen  lds
  s_add_u32 m0, m0, 1024
  s_nop 0
  s_add_u32 s58, s58, 3072
  s_cmp_eq_u32 s58, s45
  s_cselect_b32 s58, s44, s58
  s_waitcnt lgkmcnt(0)
  v_and_b32 v40, v39, v44
  v_and_b32 v41, v39, v45
  v_and_b32 v42, v39, v46
  v_and_b32 v43, v39, v47
  v_add_u32 v4, s58, v3
  v_add_u32 v6, 4, v6
  v_mfma_f32_16x16x32_bf16 v[48:51], v[40:43], v[8:11], v[48:51]
  v_mfma_f32_16x16x32_bf16 v[52:55], v[40:43], v[12:15], v[52:55]
  v_mfma_f32_16x16x32_bf16 v[56:59], v[40:43], v[16:19], v[56:59]
  ds_bpermute_b32 v39, v6, v37
  s_waitcnt lgkmcnt(0)
  v_and_b32 v40, v39, v44
  v_and_b32 v41, v39, v45
  v_and_b32 v42, v39, v46
  v_and_b32 v43, v39, v47
  s_waitcnt vmcnt(4)
  buffer_load_dwordx4 v74, s[96:99], 0 offen  lds
  s_add_u32 m0, m0, 1024
  s_nop 0
  s_waitcnt vmcnt(4)
  buffer_load_dwordx4 v75, s[96:99], 0 offen  lds
  s_add_u32 m0, m0, 1024
  s_nop 0
  s_waitcnt vmcnt(4)
  ds_read_b128 v[8:11], v4
  ds_read_b128 v[12:15], v4 offset:128
  ds_read_b128 v[16:19], v4 offset:256
  buffer_load_dwordx4 v76, s[96:99], 0 offen  lds
  s_add_u32 m0, m0, 1024
  s_nop 0
  buffer_load_dwordx4 v72, s[96:99], s47 offen  lds
  s_add_u32 m0, m0, 1024
  s_nop 0
  s_waitcnt lgkmcnt(2)
  v_mfma_f32_16x16x32_bf16 v[48:51], v[40:43], v[8:11], v[48:51]
  s_waitcnt lgkmcnt(1)
  v_mfma_f32_16x16x32_bf16 v[52:55], v[40:43], v[12:15], v[52:55]
  s_waitcnt lgkmcnt(0)
  v_mfma_f32_16x16x32_bf16 v[56:59], v[40:43], v[16:19], v[56:59]
  s_mov_b32 exec_lo, 0x00ff00ff
  s_mov_b32 exec_hi, 0xff00ff00
  s_nop 3
  ds_write_b128 v62, v[48:51]
  ds_write_b128 v62, v[52:55] offset:256
  ds_write_b128 v62, v[56:59] offset:512
  s_mov_b64 exec, -1
  buffer_load_dwordx4 v73, s[96:99], s47 offen  lds
  s_add_u32 m0, m0, 1024
  s_mov_b32 exec_hi, 0
  buffer_load_dwordx4 v74, s[96:99], s47 offen  lds
  s_mov_b64 exec, -1
L_s_p2:
  s_waitcnt lgkmcnt(0)
  s_barrier
  s_waitcnt vmcnt(0)
  s_mov_b64 exec, 1
  ds_add_u32 v65, v63 offset:12
  s_mov_b64 exec, 1
  s_mov_b32 s47, 3200000
L_lw117:
  ds_read_b32 v7, v65 offset:12
  s_waitcnt lgkmcnt(0)
  v_cmp_gt_u32 vcc, 0x4, v7
  s_cbranch_vccz L_lwd118
  s_sub_u32 s47, s47, 1
  s_cbranch_scc0 L_lw117
L_lwd118:
  s_mov_b64 exec, -1
  ds_read_b64_tr_b16 v[172:173], v104 offset:0
  ds_read_b64_tr_b16 v[174:175], v104 offset:2560
  ds_read_b64_tr_b16 v[176:177], v104 offset:5120
  ds_read_b64_tr_b16 v[178:179], v104 offset:7680
  ds_read_b64_tr_b16 v[180:181], v104 offset:10240
  ds_read_b64_tr_b16 v[182:183], v104 offset:12800
  ds_read_b64_tr_b16 v[184:185], v104 offset:15360
  ds_read_b64_tr_b16 v[186:187], v104 offset:17920
  ds_read_b64_tr_b16 v[188:189], v104 offset:20480
  ds_read_b64_tr_b16 v[190:191], v104 offset:23040
  ds_read_b64_tr_b16 v[192:193], v104 offset:25600
  ds_read_b64_tr_b16 v[194:195], v104 offset:28160
  s_barrier
  ds_read_b128 v[196:199], v105 offset:0
  ds_read_b128 v[200:203], v105 offset:64
  ds_read_b128 v[204:207], v105 offset:128
  ds_read_b128 v[208:211], v105 offset:192
  ds_read_b128 v[212:215], v105 offset:256
  ds_read_b128 v[216:219], v105 offset:320
  s_waitcnt lgkmcnt(5)
  v_mfma_f32_16x16x32_bf16 v[220:223], v[196:199], v[172:175], 0
  s_waitcnt lgkmcnt(4)
  v_mfma_f32_16x16x32_bf16 v[224:227], v[200:203], v[176:179], 0
  s_waitcnt lgkmcnt(3)
  v_mfma_f32_16x16x32_bf16 v[220:223], v[204:207], v[180:183], v[220:223]
  s_waitcnt lgkmcnt(2)
  v_mfma_f32_16x16x32_bf16 v[224:227], v[208:211], v[184:187], v[224:227]
  s_waitcnt lgkmcnt(1)
  v_mfma_f32_16x16x32_bf16 v[220:223], v[212:215], v[188:191], v[220:223]
  s_waitcnt lgkmcnt(0)
  v_mfma_f32_16x16x32_bf16 v[224:227], v[216:219], v[192:195], v[224:227]
  s_mov_b64 exec, 0xffff
  s_nop 6
  v_pk_add_f32 v[68:69], v[220:221], v[224:225]
  buffer_store_dwordx4 v[68:71], v66, s[40:43], s60 offen sc1
  s_mov_b64 exec, -1
L_end:
  s_endpgm
.section .rodata,"a"
.p2align 6
.amdhsa_kernel recurrent_scan__mha_block_cached__dense_activation_relu__decode_kernel
  .amdhsa_next_free_vgpr 240
  .amdhsa_next_free_sgpr 102
  .amdhsa_accum_offset 240
  .amdhsa_group_segment_fixed_size 0
  .amdhsa_kernarg_size 88
  .amdhsa_user_sgpr_count 2
  .amdhsa_user_sgpr_kernarg_segment_ptr 1
  .amdhsa_system_sgpr_workgroup_id_x 1
.end_amdhsa_kernel
```
